```python
import torch

def _softmax(x, axis=-1):
    return torch.softmax(x, dim=axis)
def _gelu(x):
    return torch.nn.functional.gelu(x, approximate="tanh")
def _silu(x):
    return torch.nn.functional.silu(x)
def _sigmoid(x):
    return torch.sigmoid(x)
def _layernorm(x, axis=-1, eps=1e-5):
    m = x.mean(dim=axis, keepdim=True)
    v = x.var(dim=axis, keepdim=True, unbiased=False)
    return (x - m) / torch.sqrt(v + eps)
def _scatter_add(tgt, idx, src, axis=0):
    return tgt.clone().index_add_(axis, idx, src)
def _segment_sum(src, seg, n):
    out = torch.zeros((n,) + src.shape[1:], dtype=src.dtype)
    return out.index_add_(0, seg, src)
def _pad(x, pw):
    flat = tuple(v for pair in reversed(pw) for v in pair)
    return torch.nn.functional.pad(x, flat)

kernel_name = 'recurrent_scan__ssm_conv_s4d__mixer_channel_mlp__prompt'

def setup_inputs():

    _w = (lambda a: (lambda t: t.to(torch.bfloat16) if t.is_floating_point() else t)(torch.as_tensor(a)))
    def _A_setup():
        Bsz, L, D, N = 1, 2048, 640, 128
        return {
            "u": _w((lambda *s: torch.randn(*s, dtype=torch.bfloat16) * 0.05)(Bsz, L, D)),
            "log_A_real": _w((lambda *s: torch.randn(*s, dtype=torch.bfloat16) * 3.2)(D, N) * 0.5),
            "A_imag": _w((lambda *s: torch.randn(*s, dtype=torch.bfloat16) * 0.2)(D, N) * 3.14),
            "C_real": _w((lambda *s: torch.randn(*s, dtype=torch.bfloat16) * 0.8)(D, N) / N ** 0.5),
            "C_imag": _w((lambda *s: torch.randn(*s, dtype=torch.bfloat16) * 0.8)(D, N) / N ** 0.5),
            "log_dt": _w((lambda *s: torch.randn(*s, dtype=torch.bfloat16) * 0.2)(D) * 0.5 - 4.0),
            "D_skip": _w((lambda *s: torch.randn(*s, dtype=torch.bfloat16) * 0.2)(D)),
        }
    _A_in = _A_setup()

    def _B_setup():
        B, S, D, F = 1, 2048, 640, 1728
        return {
            "x": _w((lambda *s: torch.randn(*s, dtype=torch.bfloat16) * 0.05)(B, S, D)),
            "w1": _w((lambda *s: torch.randn(*s, dtype=torch.bfloat16) * 1.6)(D, F) * (D ** -0.5)),
            "b1": _w((lambda *s: torch.randn(*s, dtype=torch.bfloat16) * 0.8)(F)),
            "w2": _w((lambda *s: torch.randn(*s, dtype=torch.bfloat16) * 0.1)(F, D) * (F ** -0.5)),
            "b2": _w((lambda *s: torch.randn(*s, dtype=torch.bfloat16) * 0.1)(D)),
        }
    _B_in = _B_setup()

    return {
        "A_u": _A_in["u"],
        "A_log_A_real": _A_in["log_A_real"],
        "A_A_imag": _A_in["A_imag"],
        "A_C_real": _A_in["C_real"],
        "A_C_imag": _A_in["C_imag"],
        "A_log_dt": _A_in["log_dt"],
        "A_D_skip": _A_in["D_skip"],
        "B_x": _B_in["x"],
        "B_w1": _B_in["w1"],
        "B_b1": _B_in["b1"],
        "B_w2": _B_in["w2"],
        "B_b2": _B_in["b2"],
    }

def reference(A_u, A_log_A_real, A_A_imag, A_C_real, A_C_imag, A_log_dt, A_D_skip, B_x, B_w1, B_b1, B_w2, B_b2):
    def _A_ref(u, log_A_real, A_imag, C_real, C_imag, log_dt, D_skip):
        L = u.shape[1]
        dt = torch.exp(log_dt)
        A = -torch.exp(log_A_real) + 1j * A_imag
        C = (C_real + 1j * C_imag) * dt[:, None]
        pos = (lambda x, dt: x.to(dt))(torch.arange(L), log_dt.dtype)
        P = torch.exp((A * dt[:, None])[:, :, None] * pos[None, None, :])
        K = 2.0 * torch.einsum("dn,dnl->dl", C, P).real
        L2 = 2 * L
        u_t = (lambda x, *d: x.permute(*d))(u, 0, 2, 1)
        Kf = (lambda x, *a, **k: torch.fft.rfft(x.float(), *a, **k))(K, L2)
        Uf = (lambda x, *a, **k: torch.fft.rfft(x.float(), *a, **k))(u_t, L2)
        y = (lambda x, *a, **k: torch.fft.irfft(x, *a, **k).to(torch.bfloat16))(Uf * Kf[None, :, :], L2)[:, :, :L]
        y = (lambda x, *d: x.permute(*d))(y, 0, 2, 1)
        return y + u * D_skip[None, None, :]

    def _B_ref(x, w1, b1, w2, b2):
        y = _layernorm(x, axis=-1)
        h = _gelu(torch.einsum("bsd,df->bsf", y, w1) + b1)
        return torch.einsum("bsf,fd->bsd", h, w2) + b2

    x = A_u
    xn = _layernorm(x, axis=-1)
    s = _A_ref(xn, A_log_A_real, A_A_imag, A_C_real, A_C_imag, A_log_dt, A_D_skip)
    g = _silu(_B_ref(xn, B_w1, B_b1, B_w2, B_b2))
    return x + s * g
```

```asm
; @launch grid=(256,1,1) block=(512,1,1) lds=163840
.amdgcn_target "amdgcn-amd-amdhsa--gfx950"
.text
.globl recurrent_scan__ssm_conv_s4d__mixer_channel_mlp__prompt_kernel
.p2align 8
.type recurrent_scan__ssm_conv_s4d__mixer_channel_mlp__prompt_kernel,@function
recurrent_scan__ssm_conv_s4d__mixer_channel_mlp__prompt_kernel:
    s_cmp_ge_u32 s2, 256
    s_cbranch_scc1 L_END
    s_load_dwordx16 s[16:31], s[0:1], 0
    s_load_dwordx8 s[32:39], s[0:1], 64
    s_load_dwordx4 s[40:43], s[0:1], 96
    s_load_dwordx2 s[44:45], s[0:1], 112
    v_lshrrev_b32 v1, 6, v0
    v_and_b32 v0, 63, v0
    v_readfirstlane_b32 s3, v1
    s_and_b32 s4, s2, 7
    s_lshr_b32 s5, s2, 3
    s_add_u32 s5, s5, 4
    s_and_b32 s5, s5, 31
    s_cmp_ge_u32 s3, 4
    s_cbranch_scc1 L_AUX
    s_setprio 0
    s_and_b32 s6, s3, 3
    s_lshl_b32 s6, s6, 6
    s_add_u32 s6, s6, 163072
    v_and_b32 v9, 15, v0
    v_lshlrev_b32 v9, 2, v9
    v_add_u32 v9, s6, v9
    v_mov_b32 v11, 0
    ds_write_b32 v9, v11
    v_lshrrev_b32 v10, 4, v0
    v_and_b32 v8, 15, v0
    s_and_b32 s6, s5, 7
    s_lshr_b32 s13, s4, 1
    s_lshl3_add_u32 s13, s13, s6
    s_lshr_b32 s7, s5, 3
    s_and_b32 s14, s4, 1
    s_lshl2_add_u32 s14, s14, s7
    s_mul_i32 s15, s7, 7
    s_lshr_b32 s15, s15, 1
    s_mul_i32 s7, s5, 3
    s_lshl1_add_u32 s8, s5, 16
    s_cmp_lt_u32 s5, 16
    s_cselect_b32 s8, s7, s8
    s_cselect_b32 s7, 3, 2
    s_add_u32 s8, s8, s3
    s_mul_i32 s6, s4, 80
    s_add_u32 s8, s8, s6
    s_cmp_ge_u32 s3, s7
    s_cselect_b32 s8, 640, s8
    s_lshl_b32 s60, s8, 8
    s_lshl_b32 s61, s8, 1
    s_mov_b32 s62, s8
    v_lshlrev_b32 v117, 2, v0
    v_mov_b32 v118, 0
    s_cmp_lt_u32 s5, 4
    s_cbranch_scc1 L_IDLE
    s_sub_u32 s6, s5, 4
    s_mul_i32 s7, s6, 37
    s_lshr_b32 s7, s7, 8
    s_mul_i32 s8, s7, 7
    s_sub_u32 s6, s6, s8
    s_lshr_b32 s8, s4, 1
    s_lshl_b32 s8, s8, 2
    s_add_u32 s8, s8, s7
    s_and_b32 s9, s4, 1
    s_mul_i32 s9, s9, 7
    s_add_u32 s9, s9, s6
    s_lshl_b32 s11, s9, 8
    v_bfe_u32 v1, v0, 2, 2
    s_lshl_b32 s6, s3, 3
    v_add_u32 v1, s6, v1
    v_mul_u32_u24 v1, 3456, v1
    v_lshl_add_u32 v1, v10, 6, v1
    v_and_b32 v2, 3, v0
    v_lshl_add_u32 v1, v2, 4, v1
    v_add_u32 v2, 12800, v1
    s_lshl_b32 s6, s8, 7
    s_lshl_b32 s7, s3, 5
    s_add_u32 s6, s6, s7
    v_lshrrev_b32 v5, 3, v0
    v_add_u32 v3, s6, v5
    v_mul_u32_u24 v3, 1280, v3
    v_and_b32 v6, 7, v0
    v_lshrrev_b32 v5, 1, v5
    v_xor_b32 v6, v6, v5
    v_xor_b32 v5, 4, v6
    v_lshl_add_u32 v4, v5, 4, v3
    v_add_u32 v4, 9216, v4
    v_lshl_add_u32 v3, v6, 4, v3
    s_lshl_b32 s10, s3, 13
    s_add_u32 s10, s10, 65536
    s_waitcnt lgkmcnt(0)
    s_mov_b32 s64, s18
    s_mov_b32 s65, s19
    s_mov_b32 s66, 163840
    s_mov_b32 s67, 0x20000
    buffer_load_dword v112, v117, s[64:67], s60 offen nt
    s_mov_b32 s68, s20
    s_mov_b32 s69, s21
    s_mov_b32 s70, 163840
    s_mov_b32 s71, 0x20000
    buffer_load_dword v113, v117, s[68:71], s60 offen nt
    s_mov_b32 s72, s22
    s_mov_b32 s73, s23
    s_mov_b32 s74, 163840
    s_mov_b32 s75, 0x20000
    buffer_load_dword v114, v117, s[72:75], s60 offen nt
    s_mov_b32 s48, s24
    s_mov_b32 s49, s25
    s_mov_b32 s50, 163840
    s_mov_b32 s51, 0x20000
    buffer_load_dword v115, v117, s[48:51], s60 offen nt
    s_mov_b32 s64, s26
    s_mov_b32 s65, s27
    s_mov_b32 s66, 1280
    s_mov_b32 s67, 0x20000
    buffer_load_ushort v116, v118, s[64:67], s61 offen
    s_barrier
    s_lshl_b32 s1, s3, 11
    s_mov_b32 s56, s32
    s_mov_b32 s57, s33
    s_mov_b32 s58, 2211840
    s_mov_b32 s59, 0x20000
    s_mov_b32 s52, s16
    s_mov_b32 s53, s17
    s_mov_b32 s54, 2621440
    s_mov_b32 s55, 0x20000
    s_add_u32 m0, s1, 0
    s_add_u32 s0, s11, 0
    buffer_load_dwordx4 v1, s[56:59], s0 offen lds
    buffer_load_dwordx4 v2, s[56:59], s0 offen offset:1024 lds
    s_add_u32 m0, s10, 0
    s_mov_b32 s0, 0
    buffer_load_dwordx4 v3, s[52:55], s0 offen lds
    buffer_load_dwordx4 v4, s[52:55], s0 offen offset:1024 lds
    s_add_u32 m0, s10, 2048
    s_mov_b32 s0, 20480
    buffer_load_dwordx4 v3, s[52:55], s0 offen lds
    buffer_load_dwordx4 v4, s[52:55], s0 offen offset:1024 lds
    s_add_u32 m0, s1, 8192
    s_add_u32 s0, s11, 110592
    buffer_load_dwordx4 v1, s[56:59], s0 offen lds
    buffer_load_dwordx4 v2, s[56:59], s0 offen offset:1024 lds
    s_mov_b32 s48, s44
    s_mov_b32 s49, s45
    s_mov_b32 s50, 16777216
    s_mov_b32 s51, 0x20000
    s_mov_b32 s64, s38
    s_mov_b32 s65, s39
    s_mov_b32 s66, 1280
    s_mov_b32 s67, 0x20000
    s_mov_b32 s68, s40
    s_mov_b32 s69, s41
    s_mov_b32 s70, 2621440
    s_mov_b32 s71, 0x20000
    s_mov_b32 s72, s42
    s_mov_b32 s73, s43
    s_mov_b32 s74, 256
    s_mov_b32 s75, 0x20000
    v_lshrrev_b32 v7, 5, v0
    v_lshlrev_b32 v5, 11, v7
    v_bfe_u32 v6, v0, 2, 2
    v_lshl_add_u32 v5, v6, 6, v5
    v_bfe_u32 v6, v0, 4, 1
    v_lshl_add_u32 v5, v6, 5, v5
    v_and_b32 v6, 3, v0
    v_lshl_add_u32 v5, v6, 3, v5
    v_bfe_u32 v6, v0, 1, 3
    v_xor_b32 v6, v6, v7
    v_lshlrev_b32 v6, 4, v6
    v_and_b32 v253, 31, v0
    v_lshl_add_u32 v6, v253, 7, v6
    v_xor_b32 v244, 0, v6
    v_add_u32 v244, s10, v244
    v_xor_b32 v245, 32, v6
    v_add_u32 v245, s10, v245
    v_xor_b32 v246, 64, v6
    v_add_u32 v246, s10, v246
    v_xor_b32 v247, 96, v6
    v_add_u32 v247, s10, v247
    v_mov_b32 v252, 536870912
    v_cmp_gt_u32 vcc, 32, v0
    v_lshlrev_b32 v6, 4, v253
    v_lshlrev_b32 v253, 5, v253
    v_cndmask_b32 v6, v252, v6, vcc
    v_cndmask_b32 v7, v252, v253, vcc
    v_lshlrev_b32 v250, 2, v0
    v_add_u32 v250, 163072, v250
    s_cmp_ge_u32 s62, 640
    s_cbranch_scc1 NOH_1
    s_mul_i32 s6, s3, 8448
    s_add_u32 s6, s6, 32768
    v_lshlrev_b32 v164, 3, v0
    v_add_u32 v164, s6, v164
    v_mul_u32_u24 v165, 528, v8
    v_lshl_add_u32 v165, v10, 4, v165
    v_add_u32 v165, s6, v165
    s_mul_i32 s6, s3, 18176
    s_add_u32 s6, s6, 98304
    v_lshlrev_b32 v167, 1, v8
    v_lshl_add_u32 v167, v10, 7, v167
    v_add_u32 v167, s6, v167
    v_lshlrev_b32 v168, 2, v8
    v_lshrrev_b32 v169, 1, v10
    v_lshl_add_u32 v168, v169, 1, v168
    v_add_u32 v168, s6, v168
    v_mov_b32 v160, 1.0
    v_mov_b32 v161, 1.0
    v_mov_b32 v162, 0
    v_mov_b32 v163, 0
    s_waitcnt vmcnt(8)
    v_lshlrev_b32 v116, 16, v116
    v_mul_f32 v116, 1069066811, v116
    v_exp_f32 v116, v116
    v_lshlrev_b32 v120, 16, v112
    v_and_b32 v121, 0xffff0000, v112
    v_lshlrev_b32 v122, 16, v113
    v_and_b32 v123, 0xffff0000, v113
    v_lshlrev_b32 v124, 16, v114
    v_and_b32 v125, 0xffff0000, v114
    v_lshlrev_b32 v126, 16, v115
    v_and_b32 v127, 0xffff0000, v115
    v_cvt_pk_bf16_f32 v116, v116, v116
    v_and_b32 v116, 0xffff0000, v116
    v_mul_f32 v120, 1069066811, v120
    v_mul_f32 v121, 1069066811, v121
    v_exp_f32 v120, v120
    v_exp_f32 v121, v121
    v_add_f32 v112, v116, v116
    v_cvt_pk_bf16_f32 v113, v120, v121
    v_lshlrev_b32 v120, 16, v113
    v_and_b32 v121, 0xffff0000, v113
    v_pk_mul_f32 v[120:121], v[120:121], v[116:117] op_sel_hi:[1,0]
    v_pk_mul_f32 v[122:123], v[122:123], v[116:117] op_sel_hi:[1,0]
    v_pk_mul_f32 v[124:125], v[124:125], v[112:113] op_sel_hi:[1,0]
    v_pk_mul_f32 v[126:127], v[126:127], v[112:113] op_sel_hi:[1,0]
    v_mul_f32 v120, 0xbfb8aa3b, v120
    v_mul_f32 v122, 1042479491, v122
    v_mul_f32 v121, 0xbfb8aa3b, v121
    v_mul_f32 v123, 1042479491, v123
    v_mul_f32 v144, 0x41000000, v120
    v_mul_f32 v145, 0x41000000, v121
    v_mul_f32 v146, 0x41000000, v122
    v_mul_f32 v147, 0x41000000, v123
    v_mul_f32 v148, 0x43000000, v120
    v_mul_f32 v149, 0x43000000, v121
    v_mul_f32 v150, 0x43000000, v122
    v_mul_f32 v151, 0x43000000, v123
    v_mul_f32 v152, 0x44000000, v120
    v_mul_f32 v153, 0x44000000, v121
    v_mul_f32 v154, 0x44000000, v122
    v_mul_f32 v155, 0x44000000, v123
    v_mul_f32 v156, 0x44010000, v120
    v_mul_f32 v157, 0x44010000, v121
    v_mul_f32 v158, 0x44010000, v122
    v_mul_f32 v159, 0x44010000, v123
    v_exp_f32 v144, v144
    v_fract_f32 v146, v146
    v_exp_f32 v145, v145
    v_fract_f32 v147, v147
    v_exp_f32 v148, v148
    v_fract_f32 v150, v150
    v_exp_f32 v149, v149
    v_fract_f32 v151, v151
    v_exp_f32 v152, v152
    v_fract_f32 v154, v154
    v_exp_f32 v153, v153
    v_fract_f32 v155, v155
    v_exp_f32 v156, v156
    v_fract_f32 v158, v158
    v_exp_f32 v157, v157
    v_fract_f32 v159, v159
    v_cos_f32 v128, v146
    v_sin_f32 v130, v146
    v_cos_f32 v129, v147
    v_sin_f32 v131, v147
    v_cos_f32 v132, v150
    v_sin_f32 v134, v150
    v_cos_f32 v133, v151
    v_sin_f32 v135, v151
    v_cos_f32 v136, v154
    v_sin_f32 v138, v154
    v_cos_f32 v137, v155
    v_sin_f32 v139, v155
    v_cos_f32 v140, v158
    v_sin_f32 v142, v158
    v_cos_f32 v141, v159
    v_sin_f32 v143, v159
    v_pk_mul_f32 v[128:129], v[128:129], v[144:145]
    v_pk_mul_f32 v[130:131], v[130:131], v[144:145] neg_lo:[1,0] neg_hi:[1,0]
    v_pk_mul_f32 v[132:133], v[132:133], v[148:149]
    v_pk_mul_f32 v[134:135], v[134:135], v[148:149]
    v_pk_mul_f32 v[136:137], v[136:137], v[152:153]
    v_pk_mul_f32 v[138:139], v[138:139], v[152:153]
    v_pk_mul_f32 v[140:141], v[140:141], v[156:157]
    v_pk_mul_f32 v[142:143], v[142:143], v[156:157]
    v_pk_mul_f32 v[144:145], v[138:139], v[126:127]
    v_pk_mul_f32 v[146:147], v[142:143], v[126:127]
    v_pk_mul_f32 v[138:139], v[138:139], v[124:125]
    v_pk_mul_f32 v[142:143], v[142:143], v[124:125]
    v_pk_fma_f32 v[138:139], v[136:137], v[126:127], v[138:139]
    v_pk_fma_f32 v[142:143], v[140:141], v[126:127], v[142:143]
    v_pk_fma_f32 v[136:137], v[136:137], v[124:125], v[144:145] neg_lo:[0,0,1] neg_hi:[0,0,1]
    v_pk_fma_f32 v[140:141], v[140:141], v[124:125], v[146:147] neg_lo:[0,0,1] neg_hi:[0,0,1]
    s_add_u32 m0, s1, 16384
    s_add_u32 s0, s11, 221184
    buffer_load_dwordx4 v1, s[56:59], s0 offen lds
    buffer_load_dwordx4 v2, s[56:59], s0 offen offset:1024 lds
    s_add_u32 m0, s1, 24576
    s_add_u32 s0, s11, 331776
    buffer_load_dwordx4 v1, s[56:59], s0 offen lds
    buffer_load_dwordx4 v2, s[56:59], s0 offen offset:1024 lds
    s_mov_b32 s63, 4
    v_mov_b32 v166, v164
HY_2:
    v_cvt_pk_bf16_f32 v144, v160, v162
    v_cvt_pk_bf16_f32 v145, v161, v163
    v_pk_mul_f32 v[152:153], v[162:163], v[130:131]
    ds_write_b64 v166, v[144:145] offset:0
    v_pk_mul_f32 v[162:163], v[162:163], v[128:129]
    v_pk_fma_f32 v[162:163], v[160:161], v[130:131], v[162:163]
    v_pk_fma_f32 v[160:161], v[160:161], v[128:129], v[152:153] neg_lo:[0,0,1] neg_hi:[0,0,1]
    v_cvt_pk_bf16_f32 v148, v160, v162
    v_cvt_pk_bf16_f32 v149, v161, v163
    v_pk_mul_f32 v[152:153], v[162:163], v[130:131]
    ds_write_b64 v166, v[148:149] offset:528
    v_pk_mul_f32 v[162:163], v[162:163], v[128:129]
    v_pk_fma_f32 v[162:163], v[160:161], v[130:131], v[162:163]
    v_pk_fma_f32 v[160:161], v[160:161], v[128:129], v[152:153] neg_lo:[0,0,1] neg_hi:[0,0,1]
    v_cvt_pk_bf16_f32 v144, v160, v162
    v_cvt_pk_bf16_f32 v145, v161, v163
    v_pk_mul_f32 v[152:153], v[162:163], v[130:131]
    ds_write_b64 v166, v[144:145] offset:1056
    v_pk_mul_f32 v[162:163], v[162:163], v[128:129]
    v_pk_fma_f32 v[162:163], v[160:161], v[130:131], v[162:163]
    v_pk_fma_f32 v[160:161], v[160:161], v[128:129], v[152:153] neg_lo:[0,0,1] neg_hi:[0,0,1]
    v_cvt_pk_bf16_f32 v148, v160, v162
    v_cvt_pk_bf16_f32 v149, v161, v163
    v_pk_mul_f32 v[152:153], v[162:163], v[130:131]
    ds_write_b64 v166, v[148:149] offset:1584
    v_pk_mul_f32 v[162:163], v[162:163], v[128:129]
    v_pk_fma_f32 v[162:163], v[160:161], v[130:131], v[162:163]
    v_pk_fma_f32 v[160:161], v[160:161], v[128:129], v[152:153] neg_lo:[0,0,1] neg_hi:[0,0,1]
    v_add_u32 v166, 2112, v166
    s_sub_u32 s63, s63, 1
    s_cmp_lg_u32 s63, 0
    s_cbranch_scc1 HY_2
    ds_read_b128 v[176:179], v165 offset:0
    ds_read_b128 v[180:183], v165 offset:64
    ds_read_b128 v[184:187], v165 offset:128
    ds_read_b128 v[188:191], v165 offset:192
    ds_read_b128 v[192:195], v165 offset:256
    ds_read_b128 v[196:199], v165 offset:320
    ds_read_b128 v[200:203], v165 offset:384
    ds_read_b128 v[204:207], v165 offset:448
    s_add_u32 m0, s10, 4096
    s_mov_b32 s0, 128
    buffer_load_dwordx4 v3, s[52:55], s0 offen lds
    buffer_load_dwordx4 v4, s[52:55], s0 offen offset:1024 lds
    s_add_u32 m0, s10, 6144
    s_mov_b32 s0, 20608
    buffer_load_dwordx4 v3, s[52:55], s0 offen lds
    buffer_load_dwordx4 v4, s[52:55], s0 offen offset:1024 lds
    v_cvt_pk_bf16_f32 v144, v136, v138
    v_cvt_pk_bf16_f32 v145, v137, v139
    v_cvt_pk_bf16_f32 v146, v140, v142
    v_cvt_pk_bf16_f32 v147, v141, v143
    v_pk_mul_f32 v[152:153], v[138:139], v[134:135]
    v_pk_mul_f32 v[154:155], v[142:143], v[134:135]
    ds_write_b64 v164, v[144:145] offset:0
    ds_write_b64 v164, v[146:147] offset:6336
    v_pk_mul_f32 v[138:139], v[138:139], v[132:133]
    v_pk_mul_f32 v[142:143], v[142:143], v[132:133]
    v_pk_fma_f32 v[138:139], v[136:137], v[134:135], v[138:139]
    v_pk_fma_f32 v[142:143], v[140:141], v[134:135], v[142:143]
    v_pk_fma_f32 v[136:137], v[136:137], v[132:133], v[152:153] neg_lo:[0,0,1] neg_hi:[0,0,1]
    v_pk_fma_f32 v[140:141], v[140:141], v[132:133], v[154:155] neg_lo:[0,0,1] neg_hi:[0,0,1]
    v_cvt_pk_bf16_f32 v148, v136, v138
    v_cvt_pk_bf16_f32 v149, v137, v139
    v_cvt_pk_bf16_f32 v150, v140, v142
    v_cvt_pk_bf16_f32 v151, v141, v143
    v_pk_mul_f32 v[152:153], v[138:139], v[134:135]
    v_pk_mul_f32 v[154:155], v[142:143], v[134:135]
    ds_write_b64 v164, v[148:149] offset:528
    ds_write_b64 v164, v[150:151] offset:6864
    v_pk_mul_f32 v[138:139], v[138:139], v[132:133]
    v_pk_mul_f32 v[142:143], v[142:143], v[132:133]
    v_pk_fma_f32 v[138:139], v[136:137], v[134:135], v[138:139]
    v_pk_fma_f32 v[142:143], v[140:141], v[134:135], v[142:143]
    v_pk_fma_f32 v[136:137], v[136:137], v[132:133], v[152:153] neg_lo:[0,0,1] neg_hi:[0,0,1]
    v_pk_fma_f32 v[140:141], v[140:141], v[132:133], v[154:155] neg_lo:[0,0,1] neg_hi:[0,0,1]
    v_cvt_pk_bf16_f32 v144, v136, v138
    v_cvt_pk_bf16_f32 v145, v137, v139
    v_cvt_pk_bf16_f32 v146, v140, v142
    v_cvt_pk_bf16_f32 v147, v141, v143
    v_pk_mul_f32 v[152:153], v[138:139], v[134:135]
    v_pk_mul_f32 v[154:155], v[142:143], v[134:135]
    ds_write_b64 v164, v[144:145] offset:1056
    ds_write_b64 v164, v[146:147] offset:7392
    v_pk_mul_f32 v[138:139], v[138:139], v[132:133]
    v_pk_mul_f32 v[142:143], v[142:143], v[132:133]
    v_pk_fma_f32 v[138:139], v[136:137], v[134:135], v[138:139]
    v_pk_fma_f32 v[142:143], v[140:141], v[134:135], v[142:143]
    v_pk_fma_f32 v[136:137], v[136:137], v[132:133], v[152:153] neg_lo:[0,0,1] neg_hi:[0,0,1]
    v_pk_fma_f32 v[140:141], v[140:141], v[132:133], v[154:155] neg_lo:[0,0,1] neg_hi:[0,0,1]
    v_cvt_pk_bf16_f32 v148, v136, v138
    v_cvt_pk_bf16_f32 v149, v137, v139
    v_cvt_pk_bf16_f32 v150, v140, v142
    v_cvt_pk_bf16_f32 v151, v141, v143
    v_pk_mul_f32 v[152:153], v[138:139], v[134:135]
    v_pk_mul_f32 v[154:155], v[142:143], v[134:135]
    ds_write_b64 v164, v[148:149] offset:1584
    ds_write_b64 v164, v[150:151] offset:7920
    v_pk_mul_f32 v[138:139], v[138:139], v[132:133]
    v_pk_mul_f32 v[142:143], v[142:143], v[132:133]
    v_pk_fma_f32 v[138:139], v[136:137], v[134:135], v[138:139]
    v_pk_fma_f32 v[142:143], v[140:141], v[134:135], v[142:143]
    v_pk_fma_f32 v[136:137], v[136:137], v[132:133], v[152:153] neg_lo:[0,0,1] neg_hi:[0,0,1]
    v_pk_fma_f32 v[140:141], v[140:141], v[132:133], v[154:155] neg_lo:[0,0,1] neg_hi:[0,0,1]
    v_cvt_pk_bf16_f32 v144, v136, v138
    v_cvt_pk_bf16_f32 v145, v137, v139
    v_pk_mul_f32 v[152:153], v[138:139], v[134:135]
    ds_write_b64 v164, v[144:145] offset:2112
    v_pk_mul_f32 v[138:139], v[138:139], v[132:133]
    v_pk_fma_f32 v[138:139], v[136:137], v[134:135], v[138:139]
    v_pk_fma_f32 v[136:137], v[136:137], v[132:133], v[152:153] neg_lo:[0,0,1] neg_hi:[0,0,1]
    v_cvt_pk_bf16_f32 v148, v136, v138
    v_cvt_pk_bf16_f32 v149, v137, v139
    v_pk_mul_f32 v[152:153], v[138:139], v[134:135]
    ds_write_b64 v164, v[148:149] offset:2640
    v_pk_mul_f32 v[138:139], v[138:139], v[132:133]
    v_pk_fma_f32 v[138:139], v[136:137], v[134:135], v[138:139]
    v_pk_fma_f32 v[136:137], v[136:137], v[132:133], v[152:153] neg_lo:[0,0,1] neg_hi:[0,0,1]
    v_cvt_pk_bf16_f32 v144, v136, v138
    v_cvt_pk_bf16_f32 v145, v137, v139
    v_pk_mul_f32 v[152:153], v[138:139], v[134:135]
    ds_write_b64 v164, v[144:145] offset:3168
    v_pk_mul_f32 v[138:139], v[138:139], v[132:133]
    v_pk_fma_f32 v[138:139], v[136:137], v[134:135], v[138:139]
    v_pk_fma_f32 v[136:137], v[136:137], v[132:133], v[152:153] neg_lo:[0,0,1] neg_hi:[0,0,1]
    v_cvt_pk_bf16_f32 v148, v136, v138
    v_cvt_pk_bf16_f32 v149, v137, v139
    v_pk_mul_f32 v[152:153], v[138:139], v[134:135]
    ds_write_b64 v164, v[148:149] offset:3696
    v_pk_mul_f32 v[138:139], v[138:139], v[132:133]
    v_pk_fma_f32 v[138:139], v[136:137], v[134:135], v[138:139]
    v_pk_fma_f32 v[136:137], v[136:137], v[132:133], v[152:153] neg_lo:[0,0,1] neg_hi:[0,0,1]
    v_cvt_pk_bf16_f32 v144, v136, v138
    v_cvt_pk_bf16_f32 v145, v137, v139
    v_pk_mul_f32 v[152:153], v[138:139], v[134:135]
    ds_write_b64 v164, v[144:145] offset:4224
    v_pk_mul_f32 v[138:139], v[138:139], v[132:133]
    v_pk_fma_f32 v[138:139], v[136:137], v[134:135], v[138:139]
    v_pk_fma_f32 v[136:137], v[136:137], v[132:133], v[152:153] neg_lo:[0,0,1] neg_hi:[0,0,1]
    v_cvt_pk_bf16_f32 v148, v136, v138
    v_cvt_pk_bf16_f32 v149, v137, v139
    v_pk_mul_f32 v[152:153], v[138:139], v[134:135]
    ds_write_b64 v164, v[148:149] offset:4752
    v_pk_mul_f32 v[138:139], v[138:139], v[132:133]
    v_pk_fma_f32 v[138:139], v[136:137], v[134:135], v[138:139]
    v_pk_fma_f32 v[136:137], v[136:137], v[132:133], v[152:153] neg_lo:[0,0,1] neg_hi:[0,0,1]
    v_cvt_pk_bf16_f32 v144, v136, v138
    v_cvt_pk_bf16_f32 v145, v137, v139
    v_pk_mul_f32 v[152:153], v[138:139], v[134:135]
    ds_write_b64 v164, v[144:145] offset:5280
    v_pk_mul_f32 v[138:139], v[138:139], v[132:133]
    v_pk_fma_f32 v[138:139], v[136:137], v[134:135], v[138:139]
    v_pk_fma_f32 v[136:137], v[136:137], v[132:133], v[152:153] neg_lo:[0,0,1] neg_hi:[0,0,1]
    v_cvt_pk_bf16_f32 v148, v136, v138
    v_cvt_pk_bf16_f32 v149, v137, v139
    v_pk_mul_f32 v[152:153], v[138:139], v[134:135]
    ds_write_b64 v164, v[148:149] offset:5808
    v_pk_mul_f32 v[138:139], v[138:139], v[132:133]
    v_pk_fma_f32 v[138:139], v[136:137], v[134:135], v[138:139]
    v_pk_fma_f32 v[136:137], v[136:137], v[132:133], v[152:153] neg_lo:[0,0,1] neg_hi:[0,0,1]
    ds_read_b128 v[208:211], v165 offset:0
    ds_read_b128 v[212:215], v165 offset:64
    ds_read_b128 v[216:219], v165 offset:128
    ds_read_b128 v[220:223], v165 offset:192
    ds_read_b128 v[224:227], v165 offset:256
    ds_read_b128 v[228:231], v165 offset:320
    ds_read_b128 v[232:235], v165 offset:384
    ds_read_b128 v[236:239], v165 offset:448
    s_waitcnt lgkmcnt(7)
    v_mfma_f32_16x16x32_bf16 v[240:243], v[208:211], v[176:179], 0
    s_waitcnt lgkmcnt(6)
    v_mfma_f32_16x16x32_bf16 v[240:243], v[212:215], v[180:183], v[240:243]
    s_waitcnt lgkmcnt(5)
    v_mfma_f32_16x16x32_bf16 v[240:243], v[216:219], v[184:187], v[240:243]
    s_waitcnt lgkmcnt(4)
    v_mfma_f32_16x16x32_bf16 v[240:243], v[220:223], v[188:191], v[240:243]
    s_waitcnt lgkmcnt(3)
    v_mfma_f32_16x16x32_bf16 v[240:243], v[224:227], v[192:195], v[240:243]
    s_waitcnt lgkmcnt(2)
    v_mfma_f32_16x16x32_bf16 v[240:243], v[228:231], v[196:199], v[240:243]
    s_waitcnt lgkmcnt(1)
    v_mfma_f32_16x16x32_bf16 v[240:243], v[232:235], v[200:203], v[240:243]
    s_waitcnt lgkmcnt(0)
    v_mfma_f32_16x16x32_bf16 v[240:243], v[236:239], v[204:207], v[240:243]
    s_nop 7
    v_cvt_pk_bf16_f32 v144, v240, v240
    v_cvt_pk_bf16_f32 v145, v241, v241
    v_cvt_pk_bf16_f32 v146, v242, v242
    v_cvt_pk_bf16_f32 v147, v243, v243
    s_mov_b32 exec_lo, 0xffff
    s_mov_b32 exec_hi, 0xffff0000
    ds_write_b16 v168, v144 offset:768
    ds_write_b16 v168, v145 offset:832
    ds_write_b16 v168, v146 offset:896
    ds_write_b16 v168, v147 offset:960
    s_mov_b32 exec_lo, 0xffff0000
    s_mov_b32 exec_hi, 0xffff
    ds_write_b16 v167, v144 offset:896
    ds_write_b16 v167, v145 offset:928
    ds_write_b16 v167, v146 offset:960
    ds_write_b16 v167, v147 offset:992
    s_mov_b64 exec, -1
    s_branch NOH_1_j
NOH_1:
    s_add_u32 m0, s1, 16384
    s_add_u32 s0, s11, 221184
    buffer_load_dwordx4 v1, s[56:59], s0 offen lds
    buffer_load_dwordx4 v2, s[56:59], s0 offen offset:1024 lds
    s_add_u32 m0, s1, 24576
    s_add_u32 s0, s11, 331776
    buffer_load_dwordx4 v1, s[56:59], s0 offen lds
    buffer_load_dwordx4 v2, s[56:59], s0 offen offset:1024 lds
    s_add_u32 m0, s10, 4096
    s_mov_b32 s0, 128
    buffer_load_dwordx4 v3, s[52:55], s0 offen lds
    buffer_load_dwordx4 v4, s[52:55], s0 offen offset:1024 lds
    s_add_u32 m0, s10, 6144
    s_mov_b32 s0, 20608
    buffer_load_dwordx4 v3, s[52:55], s0 offen lds
    buffer_load_dwordx4 v4, s[52:55], s0 offen offset:1024 lds
NOH_1_j:
    v_mov_b32 v10, v250
    s_waitcnt vmcnt(8)
    v_add_u32 v11, 1, v11
    ds_write_b32 v9, v11
    ds_read_b32 v250, v10
    ds_read_b128 v[48:51], v244 offset:0
    ds_read_b128 v[52:55], v245 offset:0
    ds_read_b128 v[56:59], v246 offset:0
    ds_read_b128 v[60:63], v247 offset:0
    s_waitcnt lgkmcnt(4)
    v_cmp_gt_u32 vcc, v11, v250
    s_nop 0
    s_cbranch_vccnz SPIN_3
BACK_4:
    ds_read_b64_tr_b16 v[80:81], v5 offset:0
    ds_read_b64_tr_b16 v[82:83], v5 offset:1024
    ds_read_b64_tr_b16 v[84:85], v5 offset:256
    ds_read_b64_tr_b16 v[86:87], v5 offset:1280
    ds_read_b64_tr_b16 v[88:89], v5 offset:512
    ds_read_b64_tr_b16 v[90:91], v5 offset:1536
    ds_read_b64_tr_b16 v[92:93], v5 offset:768
    ds_read_b64_tr_b16 v[94:95], v5 offset:1792
    ds_read_b64_tr_b16 v[96:97], v5 offset:4096
    ds_read_b64_tr_b16 v[98:99], v5 offset:5120
    ds_read_b64_tr_b16 v[100:101], v5 offset:4352
    ds_read_b64_tr_b16 v[102:103], v5 offset:5376
    ds_read_b64_tr_b16 v[104:105], v5 offset:4608
    ds_read_b64_tr_b16 v[106:107], v5 offset:5632
    ds_read_b64_tr_b16 v[108:109], v5 offset:4864
    ds_read_b64_tr_b16 v[110:111], v5 offset:5888
    s_waitcnt lgkmcnt(12)
    v_mfma_f32_32x32x16_bf16 v[112:127], v[80:83], v[48:51], 0
    ds_read_b64_tr_b16 v[80:81], v5 offset:8192
    ds_read_b64_tr_b16 v[82:83], v5 offset:9216
    s_add_u32 m0, s1, 32768
    s_add_u32 s0, s11, 442368
    buffer_load_dwordx4 v1, s[56:59], s0 offen lds
    v_mfma_f32_32x32x16_bf16 v[128:143], v[84:87], v[48:51], 0
    ds_read_b64_tr_b16 v[84:85], v5 offset:8448
    ds_read_b64_tr_b16 v[86:87], v5 offset:9472
    buffer_load_dwordx4 v2, s[56:59], s0 offen offset:1024 lds
    s_waitcnt lgkmcnt(12)
    v_mfma_f32_32x32x16_bf16 v[144:159], v[88:91], v[48:51], 0
    ds_read_b64_tr_b16 v[88:89], v5 offset:8704
    ds_read_b64_tr_b16 v[90:91], v5 offset:9728
    s_add_u32 m0, s1, 40960
    s_add_u32 s0, s11, 552960
    buffer_load_dwordx4 v1, s[56:59], s0 offen lds
    v_mfma_f32_32x32x16_bf16 v[160:175], v[92:95], v[48:51], 0
    ds_read_b64_tr_b16 v[92:93], v5 offset:8960
    ds_read_b64_tr_b16 v[94:95], v5 offset:9984
    buffer_load_dwordx4 v2, s[56:59], s0 offen offset:1024 lds
    s_waitcnt vmcnt(8)
    v_add_u32 v11, 1, v11
    ds_write_b32 v9, v11
    s_waitcnt lgkmcnt(13)
    v_mfma_f32_32x32x16_bf16 v[112:127], v[96:99], v[52:55], v[112:127]
    ds_read_b64_tr_b16 v[96:97], v5 offset:12288
    ds_read_b64_tr_b16 v[98:99], v5 offset:13312
    s_add_u32 m0, s10, 0
    s_mov_b32 s0, 256
    buffer_load_dwordx4 v3, s[52:55], s0 offen lds
    v_mfma_f32_32x32x16_bf16 v[128:143], v[100:103], v[52:55], v[128:143]
    ds_read_b64_tr_b16 v[100:101], v5 offset:12544
    ds_read_b64_tr_b16 v[102:103], v5 offset:13568
    ds_read_b32 v250, v10
    s_waitcnt lgkmcnt(14)
    v_mfma_f32_32x32x16_bf16 v[144:159], v[104:107], v[52:55], v[144:159]
    ds_read_b64_tr_b16 v[104:105], v5 offset:12800
    ds_read_b64_tr_b16 v[106:107], v5 offset:13824
    buffer_load_dwordx4 v4, s[52:55], s0 offen offset:1024 lds
    v_mfma_f32_32x32x16_bf16 v[160:175], v[108:111], v[52:55], v[160:175]
    ds_read_b64_tr_b16 v[108:109], v5 offset:13056
    ds_read_b64_tr_b16 v[110:111], v5 offset:14080
    s_waitcnt lgkmcnt(4)
    v_cmp_gt_u32 vcc, v11, v250
    s_nop 0
    s_cbranch_vccnz SPIN_5
BACK_6:
    v_mfma_f32_32x32x16_bf16 v[112:127], v[80:83], v[56:59], v[112:127]
    ds_read_b64_tr_b16 v[80:81], v5 offset:16384
    ds_read_b64_tr_b16 v[82:83], v5 offset:17408
    s_add_u32 m0, s1, 49152
    s_add_u32 s0, s11, 663552
    buffer_load_dwordx4 v1, s[56:59], s0 offen lds
    v_mfma_f32_32x32x16_bf16 v[128:143], v[84:87], v[56:59], v[128:143]
    ds_read_b64_tr_b16 v[84:85], v5 offset:16640
    ds_read_b64_tr_b16 v[86:87], v5 offset:17664
    s_waitcnt vmcnt(7)
    ds_read_b128 v[64:67], v244 offset:4096
    v_mfma_f32_32x32x16_bf16 v[144:159], v[88:91], v[56:59], v[144:159]
    ds_read_b64_tr_b16 v[88:89], v5 offset:16896
    ds_read_b64_tr_b16 v[90:91], v5 offset:17920
    buffer_load_dwordx4 v2, s[56:59], s0 offen offset:1024 lds
    v_mfma_f32_32x32x16_bf16 v[160:175], v[92:95], v[56:59], v[160:175]
    ds_read_b64_tr_b16 v[92:93], v5 offset:17152
    ds_read_b64_tr_b16 v[94:95], v5 offset:18176
    ds_read_b128 v[68:71], v245 offset:4096
    v_mfma_f32_32x32x16_bf16 v[112:127], v[96:99], v[60:63], v[112:127]
    ds_read_b64_tr_b16 v[96:97], v5 offset:20480
    ds_read_b64_tr_b16 v[98:99], v5 offset:21504
    s_add_u32 m0, s10, 2048
    s_mov_b32 s0, 20736
    buffer_load_dwordx4 v3, s[52:55], s0 offen lds
    v_mfma_f32_32x32x16_bf16 v[128:143], v[100:103], v[60:63], v[128:143]
    ds_read_b64_tr_b16 v[100:101], v5 offset:20736
    ds_read_b64_tr_b16 v[102:103], v5 offset:21760
    ds_read_b128 v[72:75], v246 offset:4096
    s_waitcnt lgkmcnt(15)
    v_mfma_f32_32x32x16_bf16 v[144:159], v[104:107], v[60:63], v[144:159]
    ds_read_b64_tr_b16 v[104:105], v5 offset:20992
    ds_read_b64_tr_b16 v[106:107], v5 offset:22016
    buffer_load_dwordx4 v4, s[52:55], s0 offen offset:1024 lds
    v_mfma_f32_32x32x16_bf16 v[160:175], v[108:111], v[60:63], v[160:175]
    ds_read_b64_tr_b16 v[108:109], v5 offset:21248
    ds_read_b64_tr_b16 v[110:111], v5 offset:22272
    ds_read_b128 v[76:79], v247 offset:4096
    s_waitcnt lgkmcnt(15)
    v_mfma_f32_32x32x16_bf16 v[112:127], v[80:83], v[64:67], v[112:127]
    ds_read_b64_tr_b16 v[80:81], v5 offset:24576
    ds_read_b64_tr_b16 v[82:83], v5 offset:25600
    s_add_u32 m0, s1, 57344
    s_add_u32 s0, s11, 774144
    buffer_load_dwordx4 v1, s[56:59], s0 offen lds
    v_mfma_f32_32x32x16_bf16 v[128:143], v[84:87], v[64:67], v[128:143]
    ds_read_b64_tr_b16 v[84:85], v5 offset:24832
    ds_read_b64_tr_b16 v[86:87], v5 offset:25856
    s_waitcnt lgkmcnt(15)
    v_mfma_f32_32x32x16_bf16 v[144:159], v[88:91], v[64:67], v[144:159]
    ds_read_b64_tr_b16 v[88:89], v5 offset:25088
    ds_read_b64_tr_b16 v[90:91], v5 offset:26112
    buffer_load_dwordx4 v2, s[56:59], s0 offen offset:1024 lds
    v_mfma_f32_32x32x16_bf16 v[160:175], v[92:95], v[64:67], v[160:175]
    ds_read_b64_tr_b16 v[92:93], v5 offset:25344
    ds_read_b64_tr_b16 v[94:95], v5 offset:26368
    s_waitcnt vmcnt(8)
    v_add_u32 v11, 1, v11
    ds_write_b32 v9, v11
    s_waitcnt lgkmcnt(15)
    v_mfma_f32_32x32x16_bf16 v[112:127], v[96:99], v[68:71], v[112:127]
    ds_read_b64_tr_b16 v[96:97], v5 offset:28672
    ds_read_b64_tr_b16 v[98:99], v5 offset:29696
    s_waitcnt lgkmcnt(11)
    s_add_u32 m0, s10, 4096
    s_mov_b32 s0, 384
    buffer_load_dwordx4 v3, s[52:55], s0 offen lds
    v_mfma_f32_32x32x16_bf16 v[128:143], v[100:103], v[68:71], v[128:143]
    ds_read_b64_tr_b16 v[100:101], v5 offset:28928
    ds_read_b64_tr_b16 v[102:103], v5 offset:29952
    ds_read_b32 v250, v10
    v_mfma_f32_32x32x16_bf16 v[144:159], v[104:107], v[68:71], v[144:159]
    ds_read_b64_tr_b16 v[104:105], v5 offset:29184
    ds_read_b64_tr_b16 v[106:107], v5 offset:30208
    buffer_load_dwordx4 v4, s[52:55], s0 offen offset:1024 lds
    v_mfma_f32_32x32x16_bf16 v[160:175], v[108:111], v[68:71], v[160:175]
    ds_read_b64_tr_b16 v[108:109], v5 offset:29440
    ds_read_b64_tr_b16 v[110:111], v5 offset:30464
    s_waitcnt lgkmcnt(4)
    v_cmp_gt_u32 vcc, v11, v250
    s_nop 0
    s_cbranch_vccnz SPIN_7
BACK_8:
    v_mfma_f32_32x32x16_bf16 v[112:127], v[80:83], v[72:75], v[112:127]
    ds_read_b64_tr_b16 v[80:81], v5 offset:32768
    ds_read_b64_tr_b16 v[82:83], v5 offset:33792
    s_add_u32 m0, s1, 0
    s_add_u32 s0, s11, 884736
    buffer_load_dwordx4 v1, s[56:59], s0 offen lds
    v_mfma_f32_32x32x16_bf16 v[128:143], v[84:87], v[72:75], v[128:143]
    ds_read_b64_tr_b16 v[84:85], v5 offset:33024
    ds_read_b64_tr_b16 v[86:87], v5 offset:34048
    s_waitcnt vmcnt(5)
    ds_read_b128 v[48:51], v244 offset:0
    v_mfma_f32_32x32x16_bf16 v[144:159], v[88:91], v[72:75], v[144:159]
    ds_read_b64_tr_b16 v[88:89], v5 offset:33280
    ds_read_b64_tr_b16 v[90:91], v5 offset:34304
    buffer_load_dwordx4 v2, s[56:59], s0 offen offset:1024 lds
    v_mfma_f32_32x32x16_bf16 v[160:175], v[92:95], v[72:75], v[160:175]
    ds_read_b64_tr_b16 v[92:93], v5 offset:33536
    ds_read_b64_tr_b16 v[94:95], v5 offset:34560
    ds_read_b128 v[52:55], v245 offset:0
    v_mfma_f32_32x32x16_bf16 v[112:127], v[96:99], v[76:79], v[112:127]
    ds_read_b64_tr_b16 v[96:97], v5 offset:36864
    ds_read_b64_tr_b16 v[98:99], v5 offset:37888
    s_add_u32 m0, s10, 6144
    s_mov_b32 s0, 20864
    buffer_load_dwordx4 v3, s[52:55], s0 offen lds
    v_mfma_f32_32x32x16_bf16 v[128:143], v[100:103], v[76:79], v[128:143]
    ds_read_b64_tr_b16 v[100:101], v5 offset:37120
    ds_read_b64_tr_b16 v[102:103], v5 offset:38144
    ds_read_b128 v[56:59], v246 offset:0
    s_waitcnt lgkmcnt(15)
    v_mfma_f32_32x32x16_bf16 v[144:159], v[104:107], v[76:79], v[144:159]
    ds_read_b64_tr_b16 v[104:105], v5 offset:37376
    ds_read_b64_tr_b16 v[106:107], v5 offset:38400
    buffer_load_dwordx4 v4, s[52:55], s0 offen offset:1024 lds
    v_mfma_f32_32x32x16_bf16 v[160:175], v[108:111], v[76:79], v[160:175]
    ds_read_b64_tr_b16 v[108:109], v5 offset:37632
    ds_read_b64_tr_b16 v[110:111], v5 offset:38656
    ds_read_b128 v[60:63], v247 offset:0
    s_waitcnt lgkmcnt(15)
    v_mfma_f32_32x32x16_bf16 v[112:127], v[80:83], v[48:51], v[112:127]
    ds_read_b64_tr_b16 v[80:81], v5 offset:40960
    ds_read_b64_tr_b16 v[82:83], v5 offset:41984
    s_add_u32 m0, s1, 8192
    s_add_u32 s0, s11, 995328
    buffer_load_dwordx4 v1, s[56:59], s0 offen lds
    v_mfma_f32_32x32x16_bf16 v[128:143], v[84:87], v[48:51], v[128:143]
    ds_read_b64_tr_b16 v[84:85], v5 offset:41216
    ds_read_b64_tr_b16 v[86:87], v5 offset:42240
    s_waitcnt lgkmcnt(15)
    v_mfma_f32_32x32x16_bf16 v[144:159], v[88:91], v[48:51], v[144:159]
    ds_read_b64_tr_b16 v[88:89], v5 offset:41472
    ds_read_b64_tr_b16 v[90:91], v5 offset:42496
    buffer_load_dwordx4 v2, s[56:59], s0 offen offset:1024 lds
    v_mfma_f32_32x32x16_bf16 v[160:175], v[92:95], v[48:51], v[160:175]
    ds_read_b64_tr_b16 v[92:93], v5 offset:41728
    ds_read_b64_tr_b16 v[94:95], v5 offset:42752
    s_waitcnt vmcnt(8)
    v_add_u32 v11, 1, v11
    ds_write_b32 v9, v11
    s_waitcnt lgkmcnt(15)
    v_mfma_f32_32x32x16_bf16 v[112:127], v[96:99], v[52:55], v[112:127]
    ds_read_b64_tr_b16 v[96:97], v5 offset:45056
    ds_read_b64_tr_b16 v[98:99], v5 offset:46080
    s_waitcnt lgkmcnt(11)
    s_add_u32 m0, s10, 0
    s_mov_b32 s0, 512
    buffer_load_dwordx4 v3, s[52:55], s0 offen lds
    v_mfma_f32_32x32x16_bf16 v[128:143], v[100:103], v[52:55], v[128:143]
    ds_read_b64_tr_b16 v[100:101], v5 offset:45312
    ds_read_b64_tr_b16 v[102:103], v5 offset:46336
    ds_read_b32 v250, v10
    v_mfma_f32_32x32x16_bf16 v[144:159], v[104:107], v[52:55], v[144:159]
    ds_read_b64_tr_b16 v[104:105], v5 offset:45568
    ds_read_b64_tr_b16 v[106:107], v5 offset:46592
    buffer_load_dwordx4 v4, s[52:55], s0 offen offset:1024 lds
    v_mfma_f32_32x32x16_bf16 v[160:175], v[108:111], v[52:55], v[160:175]
    ds_read_b64_tr_b16 v[108:109], v5 offset:45824
    ds_read_b64_tr_b16 v[110:111], v5 offset:46848
    s_waitcnt lgkmcnt(4)
    v_cmp_gt_u32 vcc, v11, v250
    s_nop 0
    s_cbranch_vccnz SPIN_9
BACK_10:
    v_mfma_f32_32x32x16_bf16 v[112:127], v[80:83], v[56:59], v[112:127]
    ds_read_b64_tr_b16 v[80:81], v5 offset:49152
    ds_read_b64_tr_b16 v[82:83], v5 offset:50176
    s_add_u32 m0, s1, 16384
    s_add_u32 s0, s11, 1105920
    buffer_load_dwordx4 v1, s[56:59], s0 offen lds
    v_mfma_f32_32x32x16_bf16 v[128:143], v[84:87], v[56:59], v[128:143]
    ds_read_b64_tr_b16 v[84:85], v5 offset:49408
    ds_read_b64_tr_b16 v[86:87], v5 offset:50432
    s_waitcnt vmcnt(5)
    ds_read_b128 v[64:67], v244 offset:4096
    v_mfma_f32_32x32x16_bf16 v[144:159], v[88:91], v[56:59], v[144:159]
    ds_read_b64_tr_b16 v[88:89], v5 offset:49664
    ds_read_b64_tr_b16 v[90:91], v5 offset:50688
    buffer_load_dwordx4 v2, s[56:59], s0 offen offset:1024 lds
    v_mfma_f32_32x32x16_bf16 v[160:175], v[92:95], v[56:59], v[160:175]
    ds_read_b64_tr_b16 v[92:93], v5 offset:49920
    ds_read_b64_tr_b16 v[94:95], v5 offset:50944
    ds_read_b128 v[68:71], v245 offset:4096
    v_mfma_f32_32x32x16_bf16 v[112:127], v[96:99], v[60:63], v[112:127]
    ds_read_b64_tr_b16 v[96:97], v5 offset:53248
    ds_read_b64_tr_b16 v[98:99], v5 offset:54272
    s_add_u32 m0, s10, 2048
    s_mov_b32 s0, 20992
    buffer_load_dwordx4 v3, s[52:55], s0 offen lds
    v_mfma_f32_32x32x16_bf16 v[128:143], v[100:103], v[60:63], v[128:143]
    ds_read_b64_tr_b16 v[100:101], v5 offset:53504
    ds_read_b64_tr_b16 v[102:103], v5 offset:54528
    ds_read_b128 v[72:75], v246 offset:4096
    s_waitcnt lgkmcnt(15)
    v_mfma_f32_32x32x16_bf16 v[144:159], v[104:107], v[60:63], v[144:159]
    ds_read_b64_tr_b16 v[104:105], v5 offset:53760
    ds_read_b64_tr_b16 v[106:107], v5 offset:54784
    buffer_load_dwordx4 v4, s[52:55], s0 offen offset:1024 lds
    v_mfma_f32_32x32x16_bf16 v[160:175], v[108:111], v[60:63], v[160:175]
    ds_read_b64_tr_b16 v[108:109], v5 offset:54016
    ds_read_b64_tr_b16 v[110:111], v5 offset:55040
    ds_read_b128 v[76:79], v247 offset:4096
    s_waitcnt lgkmcnt(15)
    v_mfma_f32_32x32x16_bf16 v[112:127], v[80:83], v[64:67], v[112:127]
    ds_read_b64_tr_b16 v[80:81], v5 offset:57344
    ds_read_b64_tr_b16 v[82:83], v5 offset:58368
    s_add_u32 m0, s1, 24576
    s_add_u32 s0, s11, 1216512
    buffer_load_dwordx4 v1, s[56:59], s0 offen lds
    v_mfma_f32_32x32x16_bf16 v[128:143], v[84:87], v[64:67], v[128:143]
    ds_read_b64_tr_b16 v[84:85], v5 offset:57600
    ds_read_b64_tr_b16 v[86:87], v5 offset:58624
    s_waitcnt lgkmcnt(15)
    v_mfma_f32_32x32x16_bf16 v[144:159], v[88:91], v[64:67], v[144:159]
    ds_read_b64_tr_b16 v[88:89], v5 offset:57856
    ds_read_b64_tr_b16 v[90:91], v5 offset:58880
    buffer_load_dwordx4 v2, s[56:59], s0 offen offset:1024 lds
    v_mfma_f32_32x32x16_bf16 v[160:175], v[92:95], v[64:67], v[160:175]
    ds_read_b64_tr_b16 v[92:93], v5 offset:58112
    ds_read_b64_tr_b16 v[94:95], v5 offset:59136
    s_waitcnt vmcnt(8)
    v_add_u32 v11, 1, v11
    ds_write_b32 v9, v11
    s_waitcnt lgkmcnt(15)
    v_mfma_f32_32x32x16_bf16 v[112:127], v[96:99], v[68:71], v[112:127]
    ds_read_b64_tr_b16 v[96:97], v5 offset:61440
    ds_read_b64_tr_b16 v[98:99], v5 offset:62464
    s_waitcnt lgkmcnt(11)
    s_add_u32 m0, s10, 4096
    s_mov_b32 s0, 640
    buffer_load_dwordx4 v3, s[52:55], s0 offen lds
    v_mfma_f32_32x32x16_bf16 v[128:143], v[100:103], v[68:71], v[128:143]
    ds_read_b64_tr_b16 v[100:101], v5 offset:61696
    ds_read_b64_tr_b16 v[102:103], v5 offset:62720
    ds_read_b32 v250, v10
    v_mfma_f32_32x32x16_bf16 v[144:159], v[104:107], v[68:71], v[144:159]
    ds_read_b64_tr_b16 v[104:105], v5 offset:61952
    ds_read_b64_tr_b16 v[106:107], v5 offset:62976
    buffer_load_dwordx4 v4, s[52:55], s0 offen offset:1024 lds
    v_mfma_f32_32x32x16_bf16 v[160:175], v[108:111], v[68:71], v[160:175]
    ds_read_b64_tr_b16 v[108:109], v5 offset:62208
    ds_read_b64_tr_b16 v[110:111], v5 offset:63232
    s_waitcnt lgkmcnt(4)
    v_cmp_gt_u32 vcc, v11, v250
    s_nop 0
    s_cbranch_vccnz SPIN_11
BACK_12:
    v_mfma_f32_32x32x16_bf16 v[112:127], v[80:83], v[72:75], v[112:127]
    ds_read_b64_tr_b16 v[80:81], v5 offset:0
    ds_read_b64_tr_b16 v[82:83], v5 offset:1024
    s_add_u32 m0, s1, 32768
    s_add_u32 s0, s11, 1327104
    buffer_load_dwordx4 v1, s[56:59], s0 offen lds
    v_mfma_f32_32x32x16_bf16 v[128:143], v[84:87], v[72:75], v[128:143]
    ds_read_b64_tr_b16 v[84:85], v5 offset:256
    ds_read_b64_tr_b16 v[86:87], v5 offset:1280
    s_waitcnt vmcnt(5)
    ds_read_b128 v[48:51], v244 offset:0
    v_mfma_f32_32x32x16_bf16 v[144:159], v[88:91], v[72:75], v[144:159]
    ds_read_b64_tr_b16 v[88:89], v5 offset:512
    ds_read_b64_tr_b16 v[90:91], v5 offset:1536
    buffer_load_dwordx4 v2, s[56:59], s0 offen offset:1024 lds
    v_mfma_f32_32x32x16_bf16 v[160:175], v[92:95], v[72:75], v[160:175]
    ds_read_b64_tr_b16 v[92:93], v5 offset:768
    ds_read_b64_tr_b16 v[94:95], v5 offset:1792
    ds_read_b128 v[52:55], v245 offset:0
    v_mfma_f32_32x32x16_bf16 v[112:127], v[96:99], v[76:79], v[112:127]
    ds_read_b64_tr_b16 v[96:97], v5 offset:4096
    ds_read_b64_tr_b16 v[98:99], v5 offset:5120
    s_add_u32 m0, s10, 6144
    s_mov_b32 s0, 21120
    buffer_load_dwordx4 v3, s[52:55], s0 offen lds
    v_mfma_f32_32x32x16_bf16 v[128:143], v[100:103], v[76:79], v[128:143]
    ds_read_b64_tr_b16 v[100:101], v5 offset:4352
    ds_read_b64_tr_b16 v[102:103], v5 offset:5376
    ds_read_b128 v[56:59], v246 offset:0
    s_waitcnt lgkmcnt(15)
    v_mfma_f32_32x32x16_bf16 v[144:159], v[104:107], v[76:79], v[144:159]
    ds_read_b64_tr_b16 v[104:105], v5 offset:4608
    ds_read_b64_tr_b16 v[106:107], v5 offset:5632
    buffer_load_dwordx4 v4, s[52:55], s0 offen offset:1024 lds
    v_mfma_f32_32x32x16_bf16 v[160:175], v[108:111], v[76:79], v[160:175]
    ds_read_b64_tr_b16 v[108:109], v5 offset:4864
    ds_read_b64_tr_b16 v[110:111], v5 offset:5888
    ds_read_b128 v[60:63], v247 offset:0
    s_waitcnt lgkmcnt(15)
    v_mfma_f32_32x32x16_bf16 v[112:127], v[80:83], v[48:51], v[112:127]
    ds_read_b64_tr_b16 v[80:81], v5 offset:8192
    ds_read_b64_tr_b16 v[82:83], v5 offset:9216
    s_add_u32 m0, s1, 40960
    s_add_u32 s0, s11, 1437696
    buffer_load_dwordx4 v1, s[56:59], s0 offen lds
    v_mfma_f32_32x32x16_bf16 v[128:143], v[84:87], v[48:51], v[128:143]
    ds_read_b64_tr_b16 v[84:85], v5 offset:8448
    ds_read_b64_tr_b16 v[86:87], v5 offset:9472
    s_waitcnt lgkmcnt(15)
    v_mfma_f32_32x32x16_bf16 v[144:159], v[88:91], v[48:51], v[144:159]
    ds_read_b64_tr_b16 v[88:89], v5 offset:8704
    ds_read_b64_tr_b16 v[90:91], v5 offset:9728
    buffer_load_dwordx4 v2, s[56:59], s0 offen offset:1024 lds
    v_mfma_f32_32x32x16_bf16 v[160:175], v[92:95], v[48:51], v[160:175]
    ds_read_b64_tr_b16 v[92:93], v5 offset:8960
    ds_read_b64_tr_b16 v[94:95], v5 offset:9984
    s_waitcnt vmcnt(8)
    v_add_u32 v11, 1, v11
    ds_write_b32 v9, v11
    s_waitcnt lgkmcnt(15)
    v_mfma_f32_32x32x16_bf16 v[112:127], v[96:99], v[52:55], v[112:127]
    ds_read_b64_tr_b16 v[96:97], v5 offset:12288
    ds_read_b64_tr_b16 v[98:99], v5 offset:13312
    s_waitcnt lgkmcnt(11)
    s_add_u32 m0, s10, 0
    s_mov_b32 s0, 768
    buffer_load_dwordx4 v3, s[52:55], s0 offen lds
    v_mfma_f32_32x32x16_bf16 v[128:143], v[100:103], v[52:55], v[128:143]
    ds_read_b64_tr_b16 v[100:101], v5 offset:12544
    ds_read_b64_tr_b16 v[102:103], v5 offset:13568
    ds_read_b32 v250, v10
    v_mfma_f32_32x32x16_bf16 v[144:159], v[104:107], v[52:55], v[144:159]
    ds_read_b64_tr_b16 v[104:105], v5 offset:12800
    ds_read_b64_tr_b16 v[106:107], v5 offset:13824
    buffer_load_dwordx4 v4, s[52:55], s0 offen offset:1024 lds
    v_mfma_f32_32x32x16_bf16 v[160:175], v[108:111], v[52:55], v[160:175]
    ds_read_b64_tr_b16 v[108:109], v5 offset:13056
    ds_read_b64_tr_b16 v[110:111], v5 offset:14080
    s_waitcnt lgkmcnt(4)
    v_cmp_gt_u32 vcc, v11, v250
    s_nop 0
    s_cbranch_vccnz SPIN_13
BACK_14:
    v_mfma_f32_32x32x16_bf16 v[112:127], v[80:83], v[56:59], v[112:127]
    ds_read_b64_tr_b16 v[80:81], v5 offset:16384
    ds_read_b64_tr_b16 v[82:83], v5 offset:17408
    s_add_u32 m0, s1, 49152
    s_add_u32 s0, s11, 1548288
    buffer_load_dwordx4 v1, s[56:59], s0 offen lds
    v_mfma_f32_32x32x16_bf16 v[128:143], v[84:87], v[56:59], v[128:143]
    ds_read_b64_tr_b16 v[84:85], v5 offset:16640
    ds_read_b64_tr_b16 v[86:87], v5 offset:17664
    s_waitcnt vmcnt(5)
    ds_read_b128 v[64:67], v244 offset:4096
    v_mfma_f32_32x32x16_bf16 v[144:159], v[88:91], v[56:59], v[144:159]
    ds_read_b64_tr_b16 v[88:89], v5 offset:16896
    ds_read_b64_tr_b16 v[90:91], v5 offset:17920
    buffer_load_dwordx4 v2, s[56:59], s0 offen offset:1024 lds
    v_mfma_f32_32x32x16_bf16 v[160:175], v[92:95], v[56:59], v[160:175]
    ds_read_b64_tr_b16 v[92:93], v5 offset:17152
    ds_read_b64_tr_b16 v[94:95], v5 offset:18176
    ds_read_b128 v[68:71], v245 offset:4096
    v_mfma_f32_32x32x16_bf16 v[112:127], v[96:99], v[60:63], v[112:127]
    ds_read_b64_tr_b16 v[96:97], v5 offset:20480
    ds_read_b64_tr_b16 v[98:99], v5 offset:21504
    s_add_u32 m0, s10, 2048
    s_mov_b32 s0, 21248
    buffer_load_dwordx4 v3, s[52:55], s0 offen lds
    v_mfma_f32_32x32x16_bf16 v[128:143], v[100:103], v[60:63], v[128:143]
    ds_read_b64_tr_b16 v[100:101], v5 offset:20736
    ds_read_b64_tr_b16 v[102:103], v5 offset:21760
    ds_read_b128 v[72:75], v246 offset:4096
    s_waitcnt lgkmcnt(15)
    v_mfma_f32_32x32x16_bf16 v[144:159], v[104:107], v[60:63], v[144:159]
    ds_read_b64_tr_b16 v[104:105], v5 offset:20992
    ds_read_b64_tr_b16 v[106:107], v5 offset:22016
    buffer_load_dwordx4 v4, s[52:55], s0 offen offset:1024 lds
    v_mfma_f32_32x32x16_bf16 v[160:175], v[108:111], v[60:63], v[160:175]
    ds_read_b64_tr_b16 v[108:109], v5 offset:21248
    ds_read_b64_tr_b16 v[110:111], v5 offset:22272
    ds_read_b128 v[76:79], v247 offset:4096
    s_waitcnt lgkmcnt(15)
    v_mfma_f32_32x32x16_bf16 v[112:127], v[80:83], v[64:67], v[112:127]
    ds_read_b64_tr_b16 v[80:81], v5 offset:24576
    ds_read_b64_tr_b16 v[82:83], v5 offset:25600
    s_add_u32 m0, s1, 57344
    s_add_u32 s0, s11, 1658880
    buffer_load_dwordx4 v1, s[56:59], s0 offen lds
    v_mfma_f32_32x32x16_bf16 v[128:143], v[84:87], v[64:67], v[128:143]
    ds_read_b64_tr_b16 v[84:85], v5 offset:24832
    ds_read_b64_tr_b16 v[86:87], v5 offset:25856
    s_waitcnt lgkmcnt(15)
    v_mfma_f32_32x32x16_bf16 v[144:159], v[88:91], v[64:67], v[144:159]
    ds_read_b64_tr_b16 v[88:89], v5 offset:25088
    ds_read_b64_tr_b16 v[90:91], v5 offset:26112
    buffer_load_dwordx4 v2, s[56:59], s0 offen offset:1024 lds
    v_mfma_f32_32x32x16_bf16 v[160:175], v[92:95], v[64:67], v[160:175]
    ds_read_b64_tr_b16 v[92:93], v5 offset:25344
    ds_read_b64_tr_b16 v[94:95], v5 offset:26368
    s_waitcnt vmcnt(8)
    v_add_u32 v11, 1, v11
    ds_write_b32 v9, v11
    s_waitcnt lgkmcnt(15)
    v_mfma_f32_32x32x16_bf16 v[112:127], v[96:99], v[68:71], v[112:127]
    ds_read_b64_tr_b16 v[96:97], v5 offset:28672
    ds_read_b64_tr_b16 v[98:99], v5 offset:29696
    s_waitcnt lgkmcnt(11)
    s_add_u32 m0, s10, 4096
    s_mov_b32 s0, 896
    buffer_load_dwordx4 v3, s[52:55], s0 offen lds
    v_mfma_f32_32x32x16_bf16 v[128:143], v[100:103], v[68:71], v[128:143]
    ds_read_b64_tr_b16 v[100:101], v5 offset:28928
    ds_read_b64_tr_b16 v[102:103], v5 offset:29952
    ds_read_b32 v250, v10
    v_mfma_f32_32x32x16_bf16 v[144:159], v[104:107], v[68:71], v[144:159]
    ds_read_b64_tr_b16 v[104:105], v5 offset:29184
    ds_read_b64_tr_b16 v[106:107], v5 offset:30208
    buffer_load_dwordx4 v4, s[52:55], s0 offen offset:1024 lds
    v_mfma_f32_32x32x16_bf16 v[160:175], v[108:111], v[68:71], v[160:175]
    ds_read_b64_tr_b16 v[108:109], v5 offset:29440
    ds_read_b64_tr_b16 v[110:111], v5 offset:30464
    s_waitcnt lgkmcnt(4)
    v_cmp_gt_u32 vcc, v11, v250
    s_nop 0
    s_cbranch_vccnz SPIN_15
BACK_16:
    v_mfma_f32_32x32x16_bf16 v[112:127], v[80:83], v[72:75], v[112:127]
    ds_read_b64_tr_b16 v[80:81], v5 offset:32768
    ds_read_b64_tr_b16 v[82:83], v5 offset:33792
    s_add_u32 m0, s1, 0
    s_add_u32 s0, s11, 1769472
    buffer_load_dwordx4 v1, s[56:59], s0 offen lds
    v_mfma_f32_32x32x16_bf16 v[128:143], v[84:87], v[72:75], v[128:143]
    ds_read_b64_tr_b16 v[84:85], v5 offset:33024
    ds_read_b64_tr_b16 v[86:87], v5 offset:34048
    s_waitcnt vmcnt(5)
    ds_read_b128 v[48:51], v244 offset:0
    v_mfma_f32_32x32x16_bf16 v[144:159], v[88:91], v[72:75], v[144:159]
    ds_read_b64_tr_b16 v[88:89], v5 offset:33280
    ds_read_b64_tr_b16 v[90:91], v5 offset:34304
    buffer_load_dwordx4 v2, s[56:59], s0 offen offset:1024 lds
    v_mfma_f32_32x32x16_bf16 v[160:175], v[92:95], v[72:75], v[160:175]
    ds_read_b64_tr_b16 v[92:93], v5 offset:33536
    ds_read_b64_tr_b16 v[94:95], v5 offset:34560
    ds_read_b128 v[52:55], v245 offset:0
    v_mfma_f32_32x32x16_bf16 v[112:127], v[96:99], v[76:79], v[112:127]
    ds_read_b64_tr_b16 v[96:97], v5 offset:36864
    ds_read_b64_tr_b16 v[98:99], v5 offset:37888
    s_add_u32 m0, s10, 6144
    s_mov_b32 s0, 21376
    buffer_load_dwordx4 v3, s[52:55], s0 offen lds
    v_mfma_f32_32x32x16_bf16 v[128:143], v[100:103], v[76:79], v[128:143]
    ds_read_b64_tr_b16 v[100:101], v5 offset:37120
    ds_read_b64_tr_b16 v[102:103], v5 offset:38144
    ds_read_b128 v[56:59], v246 offset:0
    s_waitcnt lgkmcnt(15)
    v_mfma_f32_32x32x16_bf16 v[144:159], v[104:107], v[76:79], v[144:159]
    ds_read_b64_tr_b16 v[104:105], v5 offset:37376
    ds_read_b64_tr_b16 v[106:107], v5 offset:38400
    buffer_load_dwordx4 v4, s[52:55], s0 offen offset:1024 lds
    v_mfma_f32_32x32x16_bf16 v[160:175], v[108:111], v[76:79], v[160:175]
    ds_read_b64_tr_b16 v[108:109], v5 offset:37632
    ds_read_b64_tr_b16 v[110:111], v5 offset:38656
    ds_read_b128 v[60:63], v247 offset:0
    s_waitcnt lgkmcnt(15)
    v_mfma_f32_32x32x16_bf16 v[112:127], v[80:83], v[48:51], v[112:127]
    ds_read_b64_tr_b16 v[80:81], v5 offset:40960
    ds_read_b64_tr_b16 v[82:83], v5 offset:41984
    s_add_u32 m0, s1, 8192
    s_add_u32 s0, s11, 1880064
    buffer_load_dwordx4 v1, s[56:59], s0 offen lds
    v_mfma_f32_32x32x16_bf16 v[128:143], v[84:87], v[48:51], v[128:143]
    ds_read_b64_tr_b16 v[84:85], v5 offset:41216
    ds_read_b64_tr_b16 v[86:87], v5 offset:42240
    s_waitcnt lgkmcnt(15)
    v_mfma_f32_32x32x16_bf16 v[144:159], v[88:91], v[48:51], v[144:159]
    ds_read_b64_tr_b16 v[88:89], v5 offset:41472
    ds_read_b64_tr_b16 v[90:91], v5 offset:42496
    buffer_load_dwordx4 v2, s[56:59], s0 offen offset:1024 lds
    v_mfma_f32_32x32x16_bf16 v[160:175], v[92:95], v[48:51], v[160:175]
    ds_read_b64_tr_b16 v[92:93], v5 offset:41728
    ds_read_b64_tr_b16 v[94:95], v5 offset:42752
    s_waitcnt vmcnt(8)
    v_add_u32 v11, 1, v11
    ds_write_b32 v9, v11
    s_waitcnt lgkmcnt(15)
    v_mfma_f32_32x32x16_bf16 v[112:127], v[96:99], v[52:55], v[112:127]
    ds_read_b64_tr_b16 v[96:97], v5 offset:45056
    ds_read_b64_tr_b16 v[98:99], v5 offset:46080
    s_waitcnt lgkmcnt(11)
    s_add_u32 m0, s10, 0
    s_mov_b32 s0, 1024
    buffer_load_dwordx4 v3, s[52:55], s0 offen lds
    v_mfma_f32_32x32x16_bf16 v[128:143], v[100:103], v[52:55], v[128:143]
    ds_read_b64_tr_b16 v[100:101], v5 offset:45312
    ds_read_b64_tr_b16 v[102:103], v5 offset:46336
    ds_read_b32 v250, v10
    v_mfma_f32_32x32x16_bf16 v[144:159], v[104:107], v[52:55], v[144:159]
    ds_read_b64_tr_b16 v[104:105], v5 offset:45568
    ds_read_b64_tr_b16 v[106:107], v5 offset:46592
    buffer_load_dwordx4 v4, s[52:55], s0 offen offset:1024 lds
    v_mfma_f32_32x32x16_bf16 v[160:175], v[108:111], v[52:55], v[160:175]
    ds_read_b64_tr_b16 v[108:109], v5 offset:45824
    ds_read_b64_tr_b16 v[110:111], v5 offset:46848
    s_waitcnt lgkmcnt(4)
    v_cmp_gt_u32 vcc, v11, v250
    s_nop 0
    s_cbranch_vccnz SPIN_17
BACK_18:
    v_mfma_f32_32x32x16_bf16 v[112:127], v[80:83], v[56:59], v[112:127]
    ds_read_b64_tr_b16 v[80:81], v5 offset:49152
    ds_read_b64_tr_b16 v[82:83], v5 offset:50176
    s_add_u32 m0, s1, 16384
    s_add_u32 s0, s11, 1990656
    buffer_load_dwordx4 v1, s[56:59], s0 offen lds
    v_mfma_f32_32x32x16_bf16 v[128:143], v[84:87], v[56:59], v[128:143]
    ds_read_b64_tr_b16 v[84:85], v5 offset:49408
    ds_read_b64_tr_b16 v[86:87], v5 offset:50432
    s_waitcnt vmcnt(5)
    ds_read_b128 v[64:67], v244 offset:4096
    v_mfma_f32_32x32x16_bf16 v[144:159], v[88:91], v[56:59], v[144:159]
    ds_read_b64_tr_b16 v[88:89], v5 offset:49664
    ds_read_b64_tr_b16 v[90:91], v5 offset:50688
    buffer_load_dwordx4 v2, s[56:59], s0 offen offset:1024 lds
    v_mfma_f32_32x32x16_bf16 v[160:175], v[92:95], v[56:59], v[160:175]
    ds_read_b64_tr_b16 v[92:93], v5 offset:49920
    ds_read_b64_tr_b16 v[94:95], v5 offset:50944
    ds_read_b128 v[68:71], v245 offset:4096
    v_mfma_f32_32x32x16_bf16 v[112:127], v[96:99], v[60:63], v[112:127]
    ds_read_b64_tr_b16 v[96:97], v5 offset:53248
    ds_read_b64_tr_b16 v[98:99], v5 offset:54272
    s_add_u32 m0, s10, 2048
    s_mov_b32 s0, 21504
    buffer_load_dwordx4 v3, s[52:55], s0 offen lds
    v_mfma_f32_32x32x16_bf16 v[128:143], v[100:103], v[60:63], v[128:143]
    ds_read_b64_tr_b16 v[100:101], v5 offset:53504
    ds_read_b64_tr_b16 v[102:103], v5 offset:54528
    ds_read_b128 v[72:75], v246 offset:4096
    s_waitcnt lgkmcnt(15)
    v_mfma_f32_32x32x16_bf16 v[144:159], v[104:107], v[60:63], v[144:159]
    ds_read_b64_tr_b16 v[104:105], v5 offset:53760
    ds_read_b64_tr_b16 v[106:107], v5 offset:54784
    buffer_load_dwordx4 v4, s[52:55], s0 offen offset:1024 lds
    v_mfma_f32_32x32x16_bf16 v[160:175], v[108:111], v[60:63], v[160:175]
    ds_read_b64_tr_b16 v[108:109], v5 offset:54016
    ds_read_b64_tr_b16 v[110:111], v5 offset:55040
    ds_read_b128 v[76:79], v247 offset:4096
    s_waitcnt lgkmcnt(15)
    v_mfma_f32_32x32x16_bf16 v[112:127], v[80:83], v[64:67], v[112:127]
    ds_read_b64_tr_b16 v[80:81], v5 offset:57344
    ds_read_b64_tr_b16 v[82:83], v5 offset:58368
    s_add_u32 m0, s1, 24576
    s_add_u32 s0, s11, 2101248
    buffer_load_dwordx4 v1, s[56:59], s0 offen lds
    v_mfma_f32_32x32x16_bf16 v[128:143], v[84:87], v[64:67], v[128:143]
    ds_read_b64_tr_b16 v[84:85], v5 offset:57600
    ds_read_b64_tr_b16 v[86:87], v5 offset:58624
    s_waitcnt lgkmcnt(15)
    v_mfma_f32_32x32x16_bf16 v[144:159], v[88:91], v[64:67], v[144:159]
    ds_read_b64_tr_b16 v[88:89], v5 offset:57856
    ds_read_b64_tr_b16 v[90:91], v5 offset:58880
    buffer_load_dwordx4 v2, s[56:59], s0 offen offset:1024 lds
    v_mfma_f32_32x32x16_bf16 v[160:175], v[92:95], v[64:67], v[160:175]
    ds_read_b64_tr_b16 v[92:93], v5 offset:58112
    ds_read_b64_tr_b16 v[94:95], v5 offset:59136
    s_waitcnt vmcnt(8)
    v_add_u32 v11, 1, v11
    ds_write_b32 v9, v11
    s_waitcnt lgkmcnt(15)
    v_mfma_f32_32x32x16_bf16 v[112:127], v[96:99], v[68:71], v[112:127]
    ds_read_b64_tr_b16 v[96:97], v5 offset:61440
    ds_read_b64_tr_b16 v[98:99], v5 offset:62464
    s_waitcnt lgkmcnt(11)
    s_add_u32 m0, s10, 4096
    s_mov_b32 s0, 1152
    buffer_load_dwordx4 v3, s[52:55], s0 offen lds
    v_mfma_f32_32x32x16_bf16 v[128:143], v[100:103], v[68:71], v[128:143]
    ds_read_b64_tr_b16 v[100:101], v5 offset:61696
    ds_read_b64_tr_b16 v[102:103], v5 offset:62720
    ds_read_b32 v250, v10
    v_mfma_f32_32x32x16_bf16 v[144:159], v[104:107], v[68:71], v[144:159]
    ds_read_b64_tr_b16 v[104:105], v5 offset:61952
    ds_read_b64_tr_b16 v[106:107], v5 offset:62976
    buffer_load_dwordx4 v4, s[52:55], s0 offen offset:1024 lds
    v_mfma_f32_32x32x16_bf16 v[160:175], v[108:111], v[68:71], v[160:175]
    ds_read_b64_tr_b16 v[108:109], v5 offset:62208
    ds_read_b64_tr_b16 v[110:111], v5 offset:63232
    s_waitcnt lgkmcnt(4)
    v_cmp_gt_u32 vcc, v11, v250
    s_nop 0
    s_cbranch_vccnz SPIN_19
BACK_20:
    v_mfma_f32_32x32x16_bf16 v[112:127], v[80:83], v[72:75], v[112:127]
    ds_read_b64_tr_b16 v[80:81], v5 offset:0
    ds_read_b64_tr_b16 v[82:83], v5 offset:1024
    v_mfma_f32_32x32x16_bf16 v[128:143], v[84:87], v[72:75], v[128:143]
    ds_read_b64_tr_b16 v[84:85], v5 offset:256
    ds_read_b64_tr_b16 v[86:87], v5 offset:1280
    s_waitcnt vmcnt(4)
    ds_read_b128 v[48:51], v244 offset:0
    v_mfma_f32_32x32x16_bf16 v[144:159], v[88:91], v[72:75], v[144:159]
    ds_read_b64_tr_b16 v[88:89], v5 offset:512
    ds_read_b64_tr_b16 v[90:91], v5 offset:1536
    v_mfma_f32_32x32x16_bf16 v[160:175], v[92:95], v[72:75], v[160:175]
    ds_read_b64_tr_b16 v[92:93], v5 offset:768
    ds_read_b64_tr_b16 v[94:95], v5 offset:1792
    ds_read_b128 v[52:55], v245 offset:0
    v_mfma_f32_32x32x16_bf16 v[112:127], v[96:99], v[76:79], v[112:127]
    ds_read_b64_tr_b16 v[96:97], v5 offset:4096
    ds_read_b64_tr_b16 v[98:99], v5 offset:5120
    s_add_u32 m0, s10, 6144
    s_mov_b32 s0, 21632
    buffer_load_dwordx4 v3, s[52:55], s0 offen lds
    v_mfma_f32_32x32x16_bf16 v[128:143], v[100:103], v[76:79], v[128:143]
    ds_read_b64_tr_b16 v[100:101], v5 offset:4352
    ds_read_b64_tr_b16 v[102:103], v5 offset:5376
    ds_read_b128 v[56:59], v246 offset:0
    v_mov_b32 v252, 99588
    ds_read_b32 v251, v252
    s_waitcnt lgkmcnt(15)
    v_mfma_f32_32x32x16_bf16 v[144:159], v[104:107], v[76:79], v[144:159]
    ds_read_b64_tr_b16 v[104:105], v5 offset:4608
    ds_read_b64_tr_b16 v[106:107], v5 offset:5632
    buffer_load_dwordx4 v4, s[52:55], s0 offen offset:1024 lds
    v_mfma_f32_32x32x16_bf16 v[160:175], v[108:111], v[76:79], v[160:175]
    ds_read_b64_tr_b16 v[108:109], v5 offset:4864
    ds_read_b64_tr_b16 v[110:111], v5 offset:5888
    ds_read_b128 v[60:63], v247 offset:0
    s_waitcnt lgkmcnt(15)
    v_mfma_f32_32x32x16_bf16 v[112:127], v[80:83], v[48:51], v[112:127]
    ds_read_b64_tr_b16 v[80:81], v5 offset:8192
    ds_read_b64_tr_b16 v[82:83], v5 offset:9216
    s_waitcnt lgkmcnt(7)
    v_cmp_gt_u32 vcc, 1, v251
    s_nop 0
    s_cbranch_vccnz SPIN_21
BACK_22:
    s_lshl_b32 s6, s8, 12
    s_lshl_b32 s7, s3, 10
    s_add_u32 s6, s6, s7
    s_add_u32 s6, s6, 16384
    s_lshl_b32 s63, s9, 11
    s_add_u32 s63, s63, 2818048
    buffer_load_dwordx4 v[192:195], v7, s[48:51], s6 offen sc1
    v_mfma_f32_32x32x16_bf16 v[128:143], v[84:87], v[48:51], v[128:143]
    ds_read_b64_tr_b16 v[84:85], v5 offset:8448
    ds_read_b64_tr_b16 v[86:87], v5 offset:9472
    buffer_load_dwordx4 v[176:179], v6, s[48:51], s63 offen offset:0 sc1
    v_mfma_f32_32x32x16_bf16 v[144:159], v[88:91], v[48:51], v[144:159]
    ds_read_b64_tr_b16 v[88:89], v5 offset:8704
    ds_read_b64_tr_b16 v[90:91], v5 offset:9728
    buffer_load_dwordx4 v[196:199], v253, s[48:51], s6 offen offset:16 sc1
    v_mfma_f32_32x32x16_bf16 v[160:175], v[92:95], v[48:51], v[160:175]
    ds_read_b64_tr_b16 v[92:93], v5 offset:8960
    ds_read_b64_tr_b16 v[94:95], v5 offset:9984
    s_waitcnt vmcnt(7)
    v_add_u32 v11, 1, v11
    ds_write_b32 v9, v11
    v_mfma_f32_32x32x16_bf16 v[112:127], v[96:99], v[52:55], v[112:127]
    ds_read_b64_tr_b16 v[96:97], v5 offset:12288
    ds_read_b64_tr_b16 v[98:99], v5 offset:13312
    buffer_load_dwordx4 v[180:183], v6, s[48:51], s63 offen offset:512 sc1
    v_mfma_f32_32x32x16_bf16 v[128:143], v[100:103], v[52:55], v[128:143]
    ds_read_b64_tr_b16 v[100:101], v5 offset:12544
    ds_read_b64_tr_b16 v[102:103], v5 offset:13568
    ds_read_b32 v250, v10
    s_waitcnt lgkmcnt(15)
    v_mfma_f32_32x32x16_bf16 v[144:159], v[104:107], v[52:55], v[144:159]
    ds_read_b64_tr_b16 v[104:105], v5 offset:12800
    ds_read_b64_tr_b16 v[106:107], v5 offset:13824
    buffer_load_dwordx4 v[184:187], v6, s[48:51], s63 offen offset:1024 sc1
    v_mfma_f32_32x32x16_bf16 v[160:175], v[108:111], v[52:55], v[160:175]
    ds_read_b64_tr_b16 v[108:109], v5 offset:13056
    ds_read_b64_tr_b16 v[110:111], v5 offset:14080
    buffer_load_dwordx4 v[188:191], v6, s[48:51], s63 offen offset:1536 sc1
    s_waitcnt lgkmcnt(4)
    v_cmp_gt_u32 vcc, v11, v250
    s_nop 0
    s_cbranch_vccnz SPIN_23
BACK_24:
    v_mfma_f32_32x32x16_bf16 v[112:127], v[80:83], v[56:59], v[112:127]
    ds_read_b64_tr_b16 v[80:81], v5 offset:16384
    ds_read_b64_tr_b16 v[82:83], v5 offset:17408
    v_mfma_f32_32x32x16_bf16 v[128:143], v[84:87], v[56:59], v[128:143]
    ds_read_b64_tr_b16 v[84:85], v5 offset:16640
    ds_read_b64_tr_b16 v[86:87], v5 offset:17664
    s_waitcnt vmcnt(6)
    ds_read_b128 v[64:67], v244 offset:4096
    v_mfma_f32_32x32x16_bf16 v[144:159], v[88:91], v[56:59], v[144:159]
    ds_read_b64_tr_b16 v[88:89], v5 offset:16896
    ds_read_b64_tr_b16 v[90:91], v5 offset:17920
    v_mfma_f32_32x32x16_bf16 v[160:175], v[92:95], v[56:59], v[160:175]
    ds_read_b64_tr_b16 v[92:93], v5 offset:17152
    ds_read_b64_tr_b16 v[94:95], v5 offset:18176
    ds_read_b128 v[68:71], v245 offset:4096
    v_mfma_f32_32x32x16_bf16 v[112:127], v[96:99], v[60:63], v[112:127]
    ds_read_b64_tr_b16 v[96:97], v5 offset:20480
    ds_read_b64_tr_b16 v[98:99], v5 offset:21504
    v_mfma_f32_32x32x16_bf16 v[128:143], v[100:103], v[60:63], v[128:143]
    ds_read_b64_tr_b16 v[100:101], v5 offset:20736
    ds_read_b64_tr_b16 v[102:103], v5 offset:21760
    ds_read_b128 v[72:75], v246 offset:4096
    s_waitcnt lgkmcnt(15)
    v_mfma_f32_32x32x16_bf16 v[144:159], v[104:107], v[60:63], v[144:159]
    ds_read_b64_tr_b16 v[104:105], v5 offset:20992
    ds_read_b64_tr_b16 v[106:107], v5 offset:22016
    v_mfma_f32_32x32x16_bf16 v[160:175], v[108:111], v[60:63], v[160:175]
    ds_read_b64_tr_b16 v[108:109], v5 offset:21248
    ds_read_b64_tr_b16 v[110:111], v5 offset:22272
    ds_read_b128 v[76:79], v247 offset:4096
    s_waitcnt lgkmcnt(15)
    v_mfma_f32_32x32x16_bf16 v[112:127], v[80:83], v[64:67], v[112:127]
    ds_read_b64_tr_b16 v[80:81], v5 offset:24576
    ds_read_b64_tr_b16 v[82:83], v5 offset:25600
    v_mfma_f32_32x32x16_bf16 v[128:143], v[84:87], v[64:67], v[128:143]
    ds_read_b64_tr_b16 v[84:85], v5 offset:24832
    ds_read_b64_tr_b16 v[86:87], v5 offset:25856
    v_lshlrev_b32 v1, 4, v0
    s_mul_i32 s10, s14, 276480
    s_add_u32 s10, s10, 3145728
    s_mul_i32 s11, s13, 221184
    s_add_u32 s11, s11, 6291456
    s_waitcnt lgkmcnt(15)
    v_mfma_f32_32x32x16_bf16 v[144:159], v[88:91], v[64:67], v[144:159]
    ds_read_b64_tr_b16 v[88:89], v5 offset:25088
    ds_read_b64_tr_b16 v[90:91], v5 offset:26112
    v_mfma_f32_32x32x16_bf16 v[160:175], v[92:95], v[64:67], v[160:175]
    ds_read_b64_tr_b16 v[92:93], v5 offset:25344
    ds_read_b64_tr_b16 v[94:95], v5 offset:26368
    v_bfe_u32 v3, v0, 4, 1
    v_lshlrev_b32 v3, 10, v3
    v_lshrrev_b32 v4, 5, v0
    v_lshl_add_u32 v3, v4, 8, v3
    s_waitcnt lgkmcnt(14)
    v_mfma_f32_32x32x16_bf16 v[112:127], v[96:99], v[68:71], v[112:127]
    ds_read_b64_tr_b16 v[96:97], v5 offset:28672
    ds_read_b64_tr_b16 v[98:99], v5 offset:29696
    v_mfma_f32_32x32x16_bf16 v[128:143], v[100:103], v[68:71], v[128:143]
    ds_read_b64_tr_b16 v[100:101], v5 offset:28928
    ds_read_b64_tr_b16 v[102:103], v5 offset:29952
    v_and_b32 v4, 15, v0
    v_lshl_add_u32 v255, v4, 4, v3
    v_mov_b32 v2, 0
    s_waitcnt lgkmcnt(13)
    v_mfma_f32_32x32x16_bf16 v[144:159], v[104:107], v[68:71], v[144:159]
    ds_read_b64_tr_b16 v[104:105], v5 offset:29184
    ds_read_b64_tr_b16 v[106:107], v5 offset:30208
    v_mfma_f32_32x32x16_bf16 v[160:175], v[108:111], v[68:71], v[160:175]
    ds_read_b64_tr_b16 v[108:109], v5 offset:29440
    ds_read_b64_tr_b16 v[110:111], v5 offset:30464
    s_waitcnt lgkmcnt(12)
    v_mfma_f32_32x32x16_bf16 v[112:127], v[80:83], v[72:75], v[112:127]
    s_lshr_b32 s6, s3, 1
    s_lshl_b32 s7, s8, 1
    s_add_u32 s6, s6, s7
    s_mul_i32 s44, s6, 221184
    v_mfma_f32_32x32x16_bf16 v[128:143], v[84:87], v[72:75], v[128:143]
    s_and_b32 s7, s3, 1
    s_lshl_b32 s7, s7, 11
    s_add_u32 s44, s44, s7
    s_add_u32 s44, s44, 6291456
    s_waitcnt lgkmcnt(8)
    v_mfma_f32_32x32x16_bf16 v[144:159], v[88:91], v[72:75], v[144:159]
    s_mul_i32 s45, s6, 128
    s_add_u32 s45, s45, 1024
    v_mfma_f32_32x32x16_bf16 v[160:175], v[92:95], v[72:75], v[160:175]
    s_lshl_b32 s6, s9, 14
    s_add_u32 s44, s44, s6
    s_cmp_eq_u32 s9, 13
    s_cselect_b32 s43, 536870912, s44
    s_waitcnt lgkmcnt(4)
    v_mfma_f32_32x32x16_bf16 v[112:127], v[96:99], v[76:79], v[112:127]
    v_mfma_f32_32x32x16_bf16 v[128:143], v[100:103], v[76:79], v[128:143]
    s_waitcnt lgkmcnt(0)
    v_mfma_f32_32x32x16_bf16 v[144:159], v[104:107], v[76:79], v[144:159]
    v_mfma_f32_32x32x16_bf16 v[160:175], v[108:111], v[76:79], v[160:175]
    v_add_u32 v11, 1, v11
    ds_write_b32 v9, v11
    s_waitcnt vmcnt(0)
    v_mfma_f32_32x32x16_bf16 v[112:127], v[176:179], v[192:195], v[112:127]
    v_mfma_f32_32x32x16_bf16 v[128:143], v[180:183], v[192:195], v[128:143]
    v_mfma_f32_32x32x16_bf16 v[144:159], v[184:187], v[192:195], v[144:159]
    v_mfma_f32_32x32x16_bf16 v[160:175], v[188:191], v[192:195], v[160:175]
    v_mov_b32 v7, 1
    s_add_u32 s6, s44, 0
    s_nop 6
    v_pk_mul_f32 v[224:225], v[112:113], v[112:113]
    v_pk_mul_f32 v[226:227], v[114:115], v[114:115]
    v_pk_mul_f32 v[228:229], v[116:117], v[116:117]
    v_pk_mul_f32 v[230:231], v[118:119], v[118:119]
    v_pk_fma_f32 v[224:225], v[196:197], v[224:225], v[196:197] op_sel:[0,0,1] op_sel_hi:[0,1,1]
    v_pk_fma_f32 v[226:227], v[196:197], v[226:227], v[196:197] op_sel:[0,0,1] op_sel_hi:[0,1,1]
    v_pk_fma_f32 v[228:229], v[196:197], v[228:229], v[196:197] op_sel:[0,0,1] op_sel_hi:[0,1,1]
    v_pk_fma_f32 v[230:231], v[196:197], v[230:231], v[196:197] op_sel:[0,0,1] op_sel_hi:[0,1,1]
    v_pk_mul_f32 v[224:225], v[224:225], v[112:113]
    v_pk_mul_f32 v[226:227], v[226:227], v[114:115]
    v_pk_mul_f32 v[228:229], v[228:229], v[116:117]
    v_pk_mul_f32 v[230:231], v[230:231], v[118:119]
    v_exp_f32 v232, v224
    v_exp_f32 v233, v225
    v_exp_f32 v234, v226
    v_exp_f32 v235, v227
    v_exp_f32 v236, v228
    v_exp_f32 v237, v229
    v_exp_f32 v238, v230
    v_exp_f32 v239, v231
    v_pk_fma_f32 v[232:233], v[198:199], v[232:233], v[198:199] op_sel_hi:[0,1,0]
    v_pk_fma_f32 v[234:235], v[198:199], v[234:235], v[198:199] op_sel_hi:[0,1,0]
    v_pk_fma_f32 v[236:237], v[198:199], v[236:237], v[198:199] op_sel_hi:[0,1,0]
    v_pk_fma_f32 v[238:239], v[198:199], v[238:239], v[198:199] op_sel_hi:[0,1,0]
    v_rcp_f32 v232, v232
    v_rcp_f32 v233, v233
    v_rcp_f32 v234, v234
    v_rcp_f32 v235, v235
    v_rcp_f32 v236, v236
    v_rcp_f32 v237, v237
    v_rcp_f32 v238, v238
    v_rcp_f32 v239, v239
    v_pk_mul_f32 v[232:233], v[232:233], v[112:113]
    v_pk_mul_f32 v[234:235], v[234:235], v[114:115]
    v_pk_mul_f32 v[236:237], v[236:237], v[116:117]
    v_pk_mul_f32 v[238:239], v[238:239], v[118:119]
    v_cvt_pk_bf16_f32 v240, v232, v233
    v_cvt_pk_bf16_f32 v241, v234, v235
    v_cvt_pk_bf16_f32 v242, v236, v237
    v_cvt_pk_bf16_f32 v243, v238, v239
    buffer_store_dwordx4 v[240:243], v255, s[48:51], s6 offen offset:0 sc1
    v_pk_mul_f32 v[224:225], v[120:121], v[120:121]
    v_pk_mul_f32 v[226:227], v[122:123], v[122:123]
    v_pk_mul_f32 v[228:229], v[124:125], v[124:125]
    v_pk_mul_f32 v[230:231], v[126:127], v[126:127]
    v_pk_fma_f32 v[224:225], v[196:197], v[224:225], v[196:197] op_sel:[0,0,1] op_sel_hi:[0,1,1]
    v_pk_fma_f32 v[226:227], v[196:197], v[226:227], v[196:197] op_sel:[0,0,1] op_sel_hi:[0,1,1]
    v_pk_fma_f32 v[228:229], v[196:197], v[228:229], v[196:197] op_sel:[0,0,1] op_sel_hi:[0,1,1]
    v_pk_fma_f32 v[230:231], v[196:197], v[230:231], v[196:197] op_sel:[0,0,1] op_sel_hi:[0,1,1]
    v_pk_mul_f32 v[224:225], v[224:225], v[120:121]
    v_pk_mul_f32 v[226:227], v[226:227], v[122:123]
    v_pk_mul_f32 v[228:229], v[228:229], v[124:125]
    v_pk_mul_f32 v[230:231], v[230:231], v[126:127]
    v_exp_f32 v232, v224
    v_exp_f32 v233, v225
    v_exp_f32 v234, v226
    v_exp_f32 v235, v227
    v_exp_f32 v236, v228
    v_exp_f32 v237, v229
    v_exp_f32 v238, v230
    v_exp_f32 v239, v231
    v_pk_fma_f32 v[232:233], v[198:199], v[232:233], v[198:199] op_sel_hi:[0,1,0]
    v_pk_fma_f32 v[234:235], v[198:199], v[234:235], v[198:199] op_sel_hi:[0,1,0]
    v_pk_fma_f32 v[236:237], v[198:199], v[236:237], v[198:199] op_sel_hi:[0,1,0]
    v_pk_fma_f32 v[238:239], v[198:199], v[238:239], v[198:199] op_sel_hi:[0,1,0]
    v_rcp_f32 v232, v232
    v_rcp_f32 v233, v233
    v_rcp_f32 v234, v234
    v_rcp_f32 v235, v235
    v_rcp_f32 v236, v236
    v_rcp_f32 v237, v237
    v_rcp_f32 v238, v238
    v_rcp_f32 v239, v239
    v_pk_mul_f32 v[232:233], v[232:233], v[120:121]
    v_pk_mul_f32 v[234:235], v[234:235], v[122:123]
    v_pk_mul_f32 v[236:237], v[236:237], v[124:125]
    v_pk_mul_f32 v[238:239], v[238:239], v[126:127]
    v_cvt_pk_bf16_f32 v244, v232, v233
    v_cvt_pk_bf16_f32 v245, v234, v235
    v_cvt_pk_bf16_f32 v246, v236, v237
    v_cvt_pk_bf16_f32 v247, v238, v239
    buffer_store_dwordx4 v[244:247], v255, s[48:51], s6 offen offset:512 sc1
    s_add_u32 s6, s44, 4096
    v_pk_mul_f32 v[224:225], v[128:129], v[128:129]
    v_pk_mul_f32 v[226:227], v[130:131], v[130:131]
    v_pk_mul_f32 v[228:229], v[132:133], v[132:133]
    v_pk_mul_f32 v[230:231], v[134:135], v[134:135]
    v_pk_fma_f32 v[224:225], v[196:197], v[224:225], v[196:197] op_sel:[0,0,1] op_sel_hi:[0,1,1]
    v_pk_fma_f32 v[226:227], v[196:197], v[226:227], v[196:197] op_sel:[0,0,1] op_sel_hi:[0,1,1]
    v_pk_fma_f32 v[228:229], v[196:197], v[228:229], v[196:197] op_sel:[0,0,1] op_sel_hi:[0,1,1]
    v_pk_fma_f32 v[230:231], v[196:197], v[230:231], v[196:197] op_sel:[0,0,1] op_sel_hi:[0,1,1]
    v_pk_mul_f32 v[224:225], v[224:225], v[128:129]
    v_pk_mul_f32 v[226:227], v[226:227], v[130:131]
    v_pk_mul_f32 v[228:229], v[228:229], v[132:133]
    v_pk_mul_f32 v[230:231], v[230:231], v[134:135]
    v_exp_f32 v232, v224
    v_exp_f32 v233, v225
    v_exp_f32 v234, v226
    v_exp_f32 v235, v227
    v_exp_f32 v236, v228
    v_exp_f32 v237, v229
    v_exp_f32 v238, v230
    v_exp_f32 v239, v231
    v_pk_fma_f32 v[232:233], v[198:199], v[232:233], v[198:199] op_sel_hi:[0,1,0]
    v_pk_fma_f32 v[234:235], v[198:199], v[234:235], v[198:199] op_sel_hi:[0,1,0]
    v_pk_fma_f32 v[236:237], v[198:199], v[236:237], v[198:199] op_sel_hi:[0,1,0]
    v_pk_fma_f32 v[238:239], v[198:199], v[238:239], v[198:199] op_sel_hi:[0,1,0]
    v_rcp_f32 v232, v232
    v_rcp_f32 v233, v233
    v_rcp_f32 v234, v234
    v_rcp_f32 v235, v235
    v_rcp_f32 v236, v236
    v_rcp_f32 v237, v237
    v_rcp_f32 v238, v238
    v_rcp_f32 v239, v239
    v_pk_mul_f32 v[232:233], v[232:233], v[128:129]
    v_pk_mul_f32 v[234:235], v[234:235], v[130:131]
    v_pk_mul_f32 v[236:237], v[236:237], v[132:133]
    v_pk_mul_f32 v[238:239], v[238:239], v[134:135]
    v_cvt_pk_bf16_f32 v240, v232, v233
    v_cvt_pk_bf16_f32 v241, v234, v235
    v_cvt_pk_bf16_f32 v242, v236, v237
    v_cvt_pk_bf16_f32 v243, v238, v239
    buffer_store_dwordx4 v[240:243], v255, s[48:51], s6 offen offset:0 sc1
    v_pk_mul_f32 v[224:225], v[136:137], v[136:137]
    v_pk_mul_f32 v[226:227], v[138:139], v[138:139]
    v_pk_mul_f32 v[228:229], v[140:141], v[140:141]
    v_pk_mul_f32 v[230:231], v[142:143], v[142:143]
    v_pk_fma_f32 v[224:225], v[196:197], v[224:225], v[196:197] op_sel:[0,0,1] op_sel_hi:[0,1,1]
    v_pk_fma_f32 v[226:227], v[196:197], v[226:227], v[196:197] op_sel:[0,0,1] op_sel_hi:[0,1,1]
    v_pk_fma_f32 v[228:229], v[196:197], v[228:229], v[196:197] op_sel:[0,0,1] op_sel_hi:[0,1,1]
    v_pk_fma_f32 v[230:231], v[196:197], v[230:231], v[196:197] op_sel:[0,0,1] op_sel_hi:[0,1,1]
    v_pk_mul_f32 v[224:225], v[224:225], v[136:137]
    v_pk_mul_f32 v[226:227], v[226:227], v[138:139]
    v_pk_mul_f32 v[228:229], v[228:229], v[140:141]
    v_pk_mul_f32 v[230:231], v[230:231], v[142:143]
    v_exp_f32 v232, v224
    v_exp_f32 v233, v225
    v_exp_f32 v234, v226
    v_exp_f32 v235, v227
    v_exp_f32 v236, v228
    v_exp_f32 v237, v229
    v_exp_f32 v238, v230
    v_exp_f32 v239, v231
    v_pk_fma_f32 v[232:233], v[198:199], v[232:233], v[198:199] op_sel_hi:[0,1,0]
    v_pk_fma_f32 v[234:235], v[198:199], v[234:235], v[198:199] op_sel_hi:[0,1,0]
    v_pk_fma_f32 v[236:237], v[198:199], v[236:237], v[198:199] op_sel_hi:[0,1,0]
    v_pk_fma_f32 v[238:239], v[198:199], v[238:239], v[198:199] op_sel_hi:[0,1,0]
    v_rcp_f32 v232, v232
    v_rcp_f32 v233, v233
    v_rcp_f32 v234, v234
    v_rcp_f32 v235, v235
    v_rcp_f32 v236, v236
    v_rcp_f32 v237, v237
    v_rcp_f32 v238, v238
    v_rcp_f32 v239, v239
    v_pk_mul_f32 v[232:233], v[232:233], v[136:137]
    v_pk_mul_f32 v[234:235], v[234:235], v[138:139]
    v_pk_mul_f32 v[236:237], v[236:237], v[140:141]
    v_pk_mul_f32 v[238:239], v[238:239], v[142:143]
    v_cvt_pk_bf16_f32 v244, v232, v233
    v_cvt_pk_bf16_f32 v245, v234, v235
    v_cvt_pk_bf16_f32 v246, v236, v237
    v_cvt_pk_bf16_f32 v247, v238, v239
    buffer_store_dwordx4 v[244:247], v255, s[48:51], s6 offen offset:512 sc1
    s_add_u32 s6, s43, 8192
    v_pk_mul_f32 v[224:225], v[144:145], v[144:145]
    v_pk_mul_f32 v[226:227], v[146:147], v[146:147]
    v_pk_mul_f32 v[228:229], v[148:149], v[148:149]
    v_pk_mul_f32 v[230:231], v[150:151], v[150:151]
    v_pk_fma_f32 v[224:225], v[196:197], v[224:225], v[196:197] op_sel:[0,0,1] op_sel_hi:[0,1,1]
    v_pk_fma_f32 v[226:227], v[196:197], v[226:227], v[196:197] op_sel:[0,0,1] op_sel_hi:[0,1,1]
    v_pk_fma_f32 v[228:229], v[196:197], v[228:229], v[196:197] op_sel:[0,0,1] op_sel_hi:[0,1,1]
    v_pk_fma_f32 v[230:231], v[196:197], v[230:231], v[196:197] op_sel:[0,0,1] op_sel_hi:[0,1,1]
    v_pk_mul_f32 v[224:225], v[224:225], v[144:145]
    v_pk_mul_f32 v[226:227], v[226:227], v[146:147]
    v_pk_mul_f32 v[228:229], v[228:229], v[148:149]
    v_pk_mul_f32 v[230:231], v[230:231], v[150:151]
    v_exp_f32 v232, v224
    v_exp_f32 v233, v225
    v_exp_f32 v234, v226
    v_exp_f32 v235, v227
    v_exp_f32 v236, v228
    v_exp_f32 v237, v229
    v_exp_f32 v238, v230
    v_exp_f32 v239, v231
    v_pk_fma_f32 v[232:233], v[198:199], v[232:233], v[198:199] op_sel_hi:[0,1,0]
    v_pk_fma_f32 v[234:235], v[198:199], v[234:235], v[198:199] op_sel_hi:[0,1,0]
    v_pk_fma_f32 v[236:237], v[198:199], v[236:237], v[198:199] op_sel_hi:[0,1,0]
    v_pk_fma_f32 v[238:239], v[198:199], v[238:239], v[198:199] op_sel_hi:[0,1,0]
    v_rcp_f32 v232, v232
    v_rcp_f32 v233, v233
    v_rcp_f32 v234, v234
    v_rcp_f32 v235, v235
    v_rcp_f32 v236, v236
    v_rcp_f32 v237, v237
    v_rcp_f32 v238, v238
    v_rcp_f32 v239, v239
    v_pk_mul_f32 v[232:233], v[232:233], v[144:145]
    v_pk_mul_f32 v[234:235], v[234:235], v[146:147]
    v_pk_mul_f32 v[236:237], v[236:237], v[148:149]
    v_pk_mul_f32 v[238:239], v[238:239], v[150:151]
    v_cvt_pk_bf16_f32 v240, v232, v233
    v_cvt_pk_bf16_f32 v241, v234, v235
    v_cvt_pk_bf16_f32 v242, v236, v237
    v_cvt_pk_bf16_f32 v243, v238, v239
    buffer_store_dwordx4 v[240:243], v255, s[48:51], s6 offen offset:0 sc1
    v_pk_mul_f32 v[224:225], v[152:153], v[152:153]
    v_pk_mul_f32 v[226:227], v[154:155], v[154:155]
    v_pk_mul_f32 v[228:229], v[156:157], v[156:157]
    v_pk_mul_f32 v[230:231], v[158:159], v[158:159]
    v_pk_fma_f32 v[224:225], v[196:197], v[224:225], v[196:197] op_sel:[0,0,1] op_sel_hi:[0,1,1]
    v_pk_fma_f32 v[226:227], v[196:197], v[226:227], v[196:197] op_sel:[0,0,1] op_sel_hi:[0,1,1]
    v_pk_fma_f32 v[228:229], v[196:197], v[228:229], v[196:197] op_sel:[0,0,1] op_sel_hi:[0,1,1]
    v_pk_fma_f32 v[230:231], v[196:197], v[230:231], v[196:197] op_sel:[0,0,1] op_sel_hi:[0,1,1]
    v_pk_mul_f32 v[224:225], v[224:225], v[152:153]
    v_pk_mul_f32 v[226:227], v[226:227], v[154:155]
    v_pk_mul_f32 v[228:229], v[228:229], v[156:157]
    v_pk_mul_f32 v[230:231], v[230:231], v[158:159]
    v_exp_f32 v232, v224
    v_exp_f32 v233, v225
    v_exp_f32 v234, v226
    v_exp_f32 v235, v227
    v_exp_f32 v236, v228
    v_exp_f32 v237, v229
    v_exp_f32 v238, v230
    v_exp_f32 v239, v231
    v_pk_fma_f32 v[232:233], v[198:199], v[232:233], v[198:199] op_sel_hi:[0,1,0]
    v_pk_fma_f32 v[234:235], v[198:199], v[234:235], v[198:199] op_sel_hi:[0,1,0]
    v_pk_fma_f32 v[236:237], v[198:199], v[236:237], v[198:199] op_sel_hi:[0,1,0]
    v_pk_fma_f32 v[238:239], v[198:199], v[238:239], v[198:199] op_sel_hi:[0,1,0]
    v_rcp_f32 v232, v232
    v_rcp_f32 v233, v233
    v_rcp_f32 v234, v234
    v_rcp_f32 v235, v235
    v_rcp_f32 v236, v236
    v_rcp_f32 v237, v237
    v_rcp_f32 v238, v238
    v_rcp_f32 v239, v239
    v_pk_mul_f32 v[232:233], v[232:233], v[152:153]
    v_pk_mul_f32 v[234:235], v[234:235], v[154:155]
    v_pk_mul_f32 v[236:237], v[236:237], v[156:157]
    v_pk_mul_f32 v[238:239], v[238:239], v[158:159]
    v_cvt_pk_bf16_f32 v244, v232, v233
    v_cvt_pk_bf16_f32 v245, v234, v235
    v_cvt_pk_bf16_f32 v246, v236, v237
    v_cvt_pk_bf16_f32 v247, v238, v239
    buffer_store_dwordx4 v[244:247], v255, s[48:51], s6 offen offset:512 sc1
    s_add_u32 s6, s43, 12288
    v_pk_mul_f32 v[224:225], v[160:161], v[160:161]
    v_pk_mul_f32 v[226:227], v[162:163], v[162:163]
    v_pk_mul_f32 v[228:229], v[164:165], v[164:165]
    v_pk_mul_f32 v[230:231], v[166:167], v[166:167]
    v_pk_fma_f32 v[224:225], v[196:197], v[224:225], v[196:197] op_sel:[0,0,1] op_sel_hi:[0,1,1]
    v_pk_fma_f32 v[226:227], v[196:197], v[226:227], v[196:197] op_sel:[0,0,1] op_sel_hi:[0,1,1]
    v_pk_fma_f32 v[228:229], v[196:197], v[228:229], v[196:197] op_sel:[0,0,1] op_sel_hi:[0,1,1]
    v_pk_fma_f32 v[230:231], v[196:197], v[230:231], v[196:197] op_sel:[0,0,1] op_sel_hi:[0,1,1]
    v_pk_mul_f32 v[224:225], v[224:225], v[160:161]
    v_pk_mul_f32 v[226:227], v[226:227], v[162:163]
    v_pk_mul_f32 v[228:229], v[228:229], v[164:165]
    v_pk_mul_f32 v[230:231], v[230:231], v[166:167]
    v_exp_f32 v232, v224
    v_exp_f32 v233, v225
    v_exp_f32 v234, v226
    v_exp_f32 v235, v227
    v_exp_f32 v236, v228
    v_exp_f32 v237, v229
    v_exp_f32 v238, v230
    v_exp_f32 v239, v231
    v_pk_fma_f32 v[232:233], v[198:199], v[232:233], v[198:199] op_sel_hi:[0,1,0]
    v_pk_fma_f32 v[234:235], v[198:199], v[234:235], v[198:199] op_sel_hi:[0,1,0]
    v_pk_fma_f32 v[236:237], v[198:199], v[236:237], v[198:199] op_sel_hi:[0,1,0]
    v_pk_fma_f32 v[238:239], v[198:199], v[238:239], v[198:199] op_sel_hi:[0,1,0]
    v_rcp_f32 v232, v232
    v_rcp_f32 v233, v233
    v_rcp_f32 v234, v234
    v_rcp_f32 v235, v235
    v_rcp_f32 v236, v236
    v_rcp_f32 v237, v237
    v_rcp_f32 v238, v238
    v_rcp_f32 v239, v239
    v_pk_mul_f32 v[232:233], v[232:233], v[160:161]
    v_pk_mul_f32 v[234:235], v[234:235], v[162:163]
    v_pk_mul_f32 v[236:237], v[236:237], v[164:165]
    v_pk_mul_f32 v[238:239], v[238:239], v[166:167]
    v_cvt_pk_bf16_f32 v240, v232, v233
    v_cvt_pk_bf16_f32 v241, v234, v235
    v_cvt_pk_bf16_f32 v242, v236, v237
    v_cvt_pk_bf16_f32 v243, v238, v239
    buffer_store_dwordx4 v[240:243], v255, s[48:51], s6 offen offset:0 sc1
    v_pk_mul_f32 v[224:225], v[168:169], v[168:169]
    v_pk_mul_f32 v[226:227], v[170:171], v[170:171]
    v_pk_mul_f32 v[228:229], v[172:173], v[172:173]
    v_pk_mul_f32 v[230:231], v[174:175], v[174:175]
    v_pk_fma_f32 v[224:225], v[196:197], v[224:225], v[196:197] op_sel:[0,0,1] op_sel_hi:[0,1,1]
    v_pk_fma_f32 v[226:227], v[196:197], v[226:227], v[196:197] op_sel:[0,0,1] op_sel_hi:[0,1,1]
    v_pk_fma_f32 v[228:229], v[196:197], v[228:229], v[196:197] op_sel:[0,0,1] op_sel_hi:[0,1,1]
    v_pk_fma_f32 v[230:231], v[196:197], v[230:231], v[196:197] op_sel:[0,0,1] op_sel_hi:[0,1,1]
    v_pk_mul_f32 v[224:225], v[224:225], v[168:169]
    v_pk_mul_f32 v[226:227], v[226:227], v[170:171]
    v_pk_mul_f32 v[228:229], v[228:229], v[172:173]
    v_pk_mul_f32 v[230:231], v[230:231], v[174:175]
    v_exp_f32 v232, v224
    v_exp_f32 v233, v225
    v_exp_f32 v234, v226
    v_exp_f32 v235, v227
    v_exp_f32 v236, v228
    v_exp_f32 v237, v229
    v_exp_f32 v238, v230
    v_exp_f32 v239, v231
    v_pk_fma_f32 v[232:233], v[198:199], v[232:233], v[198:199] op_sel_hi:[0,1,0]
    v_pk_fma_f32 v[234:235], v[198:199], v[234:235], v[198:199] op_sel_hi:[0,1,0]
    v_pk_fma_f32 v[236:237], v[198:199], v[236:237], v[198:199] op_sel_hi:[0,1,0]
    v_pk_fma_f32 v[238:239], v[198:199], v[238:239], v[198:199] op_sel_hi:[0,1,0]
    v_rcp_f32 v232, v232
    v_rcp_f32 v233, v233
    v_rcp_f32 v234, v234
    v_rcp_f32 v235, v235
    v_rcp_f32 v236, v236
    v_rcp_f32 v237, v237
    v_rcp_f32 v238, v238
    v_rcp_f32 v239, v239
    v_pk_mul_f32 v[232:233], v[232:233], v[168:169]
    v_pk_mul_f32 v[234:235], v[234:235], v[170:171]
    v_pk_mul_f32 v[236:237], v[236:237], v[172:173]
    v_pk_mul_f32 v[238:239], v[238:239], v[174:175]
    v_cvt_pk_bf16_f32 v244, v232, v233
    v_cvt_pk_bf16_f32 v245, v234, v235
    v_cvt_pk_bf16_f32 v246, v236, v237
    v_cvt_pk_bf16_f32 v247, v238, v239
    buffer_store_dwordx4 v[244:247], v255, s[48:51], s6 offen offset:512 sc1
    v_add_u32 v11, 1, v11
    ds_write_b32 v9, v11
    s_xor_b32 s6, s3, 0
    s_lshl_b32 s6, s6, 10
    v_add_u32 v3, s6, v1
    s_xor_b32 s6, s3, 1
    s_lshl_b32 s6, s6, 10
    v_add_u32 v4, s6, v1
    s_xor_b32 s6, s3, 2
    s_lshl_b32 s6, s6, 10
    v_add_u32 v5, s6, v1
    s_xor_b32 s6, s3, 3
    s_lshl_b32 s6, s6, 10
    v_add_u32 v6, s6, v1
    v_mov_b32 v254, 99588
    v_lshrrev_b32 v8, 4, v0
    v_lshlrev_b32 v8, 3, v8
    s_mul_i32 s8, s14, 160
    s_cmp_lt_u32 s3, 2
    s_cselect_b32 s0, 14, 13
    s_cselect_b64 s[24:25], -1, 0
    s_mov_b32 s6, s15
    s_lshl2_add_u32 s7, s6, s3
    s_lshl_b32 s76, s7, 10
    s_add_u32 s6, s6, 1
    s_cmp_eq_u32 s6, s0
    s_cselect_b32 s6, 0, s6
    s_lshl2_add_u32 s7, s6, s3
    s_lshl_b32 s77, s7, 10
    s_add_u32 s6, s6, 1
    s_cmp_eq_u32 s6, s0
    s_cselect_b32 s6, 0, s6
    s_lshl2_add_u32 s7, s6, s3
    s_lshl_b32 s78, s7, 10
    s_add_u32 s6, s6, 1
    s_cmp_eq_u32 s6, s0
    s_cselect_b32 s6, 0, s6
    s_lshl2_add_u32 s7, s6, s3
    s_lshl_b32 s79, s7, 10
    s_add_u32 s6, s6, 1
    s_cmp_eq_u32 s6, s0
    s_cselect_b32 s6, 0, s6
    s_lshl2_add_u32 s7, s6, s3
    s_lshl_b32 s80, s7, 10
    s_add_u32 s6, s6, 1
    s_cmp_eq_u32 s6, s0
    s_cselect_b32 s6, 0, s6
    s_lshl2_add_u32 s7, s6, s3
    s_lshl_b32 s81, s7, 10
    s_add_u32 s6, s6, 1
    s_cmp_eq_u32 s6, s0
    s_cselect_b32 s6, 0, s6
    s_lshl2_add_u32 s7, s6, s3
    s_lshl_b32 s82, s7, 10
    s_add_u32 s6, s6, 1
    s_cmp_eq_u32 s6, s0
    s_cselect_b32 s6, 0, s6
    s_lshl2_add_u32 s7, s6, s3
    s_lshl_b32 s83, s7, 10
    s_add_u32 s6, s6, 1
    s_cmp_eq_u32 s6, s0
    s_cselect_b32 s6, 0, s6
    s_lshl2_add_u32 s7, s6, s3
    s_lshl_b32 s84, s7, 10
    s_add_u32 s6, s6, 1
    s_cmp_eq_u32 s6, s0
    s_cselect_b32 s6, 0, s6
    s_lshl2_add_u32 s7, s6, s3
    s_lshl_b32 s85, s7, 10
    s_add_u32 s6, s6, 1
    s_cmp_eq_u32 s6, s0
    s_cselect_b32 s6, 0, s6
    s_lshl2_add_u32 s7, s6, s3
    s_lshl_b32 s86, s7, 10
    s_add_u32 s6, s6, 1
    s_cmp_eq_u32 s6, s0
    s_cselect_b32 s6, 0, s6
    s_lshl2_add_u32 s7, s6, s3
    s_lshl_b32 s87, s7, 10
    s_add_u32 s6, s6, 1
    s_cmp_eq_u32 s6, s0
    s_cselect_b32 s6, 0, s6
    s_lshl2_add_u32 s7, s6, s3
    s_lshl_b32 s88, s7, 10
    s_add_u32 s6, s6, 1
    s_cmp_eq_u32 s6, s0
    s_cselect_b32 s6, 0, s6
    s_lshl2_add_u32 s7, s6, s3
    s_lshl_b32 s89, s7, 10
    s_waitcnt vmcnt(0)
    s_mov_b64 exec, 1
    buffer_atomic_add v7, v2, s[48:51], s45 offen sc1
    s_mov_b64 exec, -1
    v_lshrrev_b32 v192, 4, v0
    v_lshlrev_b32 v192, 12, v192
    v_and_b32 v193, 15, v0
    v_lshl_add_u32 v192, v193, 7, v192
    s_cmp_eq_u32 s9, 13
    s_cselect_b32 exec_hi, 0, -1
    buffer_load_dword v194, v192, s[48:51], s44 offen sc1
    s_mov_b64 exec, -1
L_G2:
    s_setprio 0
    v_mov_b32 v2, v254
    ds_read_b32 v7, v2
    s_waitcnt lgkmcnt(0)
    v_cmp_gt_u32 vcc, 2, v7
    s_nop 0
    s_cbranch_vccnz SPIN_25
BACK_26:
    v_add_u32 v8, 163584, v8
    ds_read_b64 v[122:123], v8 offset:0
    ds_read_b64 v[124:125], v8 offset:32
    ds_read_b64 v[126:127], v8 offset:64
    ds_read_b64 v[128:129], v8 offset:96
    ds_read_b64 v[130:131], v8 offset:128
    s_lshl2_add_u32 s0, s76, s10
    s_add_u32 s0, s0, s76
    buffer_load_dwordx4 v[12:15], v1, s[48:51], s0 offen offset:0 sc1
    buffer_load_dwordx4 v[16:19], v1, s[48:51], s0 offen offset:1024 sc1
    buffer_load_dwordx4 v[20:23], v1, s[48:51], s0 offen offset:2048 sc1
    buffer_load_dwordx4 v[24:27], v1, s[48:51], s0 offen offset:3072 sc1
    s_add_u32 s0, s0, 4096
    buffer_load_dwordx4 v[28:31], v1, s[48:51], s0 offen offset:0 sc1
    s_lshl2_add_u32 s0, s77, s10
    s_add_u32 s0, s0, s77
    buffer_load_dwordx4 v[32:35], v1, s[48:51], s0 offen offset:0 sc1
    buffer_load_dwordx4 v[36:39], v1, s[48:51], s0 offen offset:1024 sc1
    buffer_load_dwordx4 v[40:43], v1, s[48:51], s0 offen offset:2048 sc1
    buffer_load_dwordx4 v[44:47], v1, s[48:51], s0 offen offset:3072 sc1
    s_add_u32 s0, s0, 4096
    buffer_load_dwordx4 v[48:51], v1, s[48:51], s0 offen offset:0 sc1
    s_lshl2_add_u32 s0, s78, s10
    s_add_u32 s0, s0, s78
    buffer_load_dwordx4 v[52:55], v1, s[48:51], s0 offen offset:0 sc1
    buffer_load_dwordx4 v[56:59], v1, s[48:51], s0 offen offset:1024 sc1
    buffer_load_dwordx4 v[60:63], v1, s[48:51], s0 offen offset:2048 sc1
    buffer_load_dwordx4 v[64:67], v1, s[48:51], s0 offen offset:3072 sc1
    s_add_u32 s0, s0, 4096
    buffer_load_dwordx4 v[68:71], v1, s[48:51], s0 offen offset:0 sc1
    s_lshl2_add_u32 s0, s79, s10
    s_add_u32 s0, s0, s79
    buffer_load_dwordx4 v[72:75], v1, s[48:51], s0 offen offset:0 sc1
    buffer_load_dwordx4 v[76:79], v1, s[48:51], s0 offen offset:1024 sc1
    buffer_load_dwordx4 v[80:83], v1, s[48:51], s0 offen offset:2048 sc1
    buffer_load_dwordx4 v[84:87], v1, s[48:51], s0 offen offset:3072 sc1
    s_add_u32 s0, s0, 4096
    buffer_load_dwordx4 v[88:91], v1, s[48:51], s0 offen offset:0 sc1
    s_lshl2_add_u32 s0, s80, s10
    s_add_u32 s0, s0, s80
    buffer_load_dwordx4 v[92:95], v1, s[48:51], s0 offen offset:0 sc1
    buffer_load_dwordx4 v[96:99], v1, s[48:51], s0 offen offset:1024 sc1
    buffer_load_dwordx4 v[100:103], v1, s[48:51], s0 offen offset:2048 sc1
    buffer_load_dwordx4 v[104:107], v1, s[48:51], s0 offen offset:3072 sc1
    s_add_u32 s0, s0, 4096
    buffer_load_dwordx4 v[108:111], v1, s[48:51], s0 offen offset:0 sc1
    ds_read_b32 v7, v2
    s_waitcnt lgkmcnt(0)
    v_cmp_gt_u32 vcc, 4, v7
    s_nop 0
    s_cbranch_vccnz SPIN_27
BACK_28:
    s_lshl2_add_u32 s6, s76, s11
    buffer_load_dwordx4 v[192:195], v3, s[48:51], s6 offen sc1
    buffer_load_dwordx4 v[196:199], v4, s[48:51], s6 offen sc1
    buffer_load_dwordx4 v[200:203], v5, s[48:51], s6 offen sc1
    buffer_load_dwordx4 v[204:207], v6, s[48:51], s6 offen sc1
    s_lshl2_add_u32 s6, s77, s11
    buffer_load_dwordx4 v[208:211], v3, s[48:51], s6 offen sc1
    buffer_load_dwordx4 v[212:215], v4, s[48:51], s6 offen sc1
    buffer_load_dwordx4 v[216:219], v5, s[48:51], s6 offen sc1
    buffer_load_dwordx4 v[220:223], v6, s[48:51], s6 offen sc1
    s_lshl2_add_u32 s6, s78, s11
    buffer_load_dwordx4 v[224:227], v3, s[48:51], s6 offen sc1
    buffer_load_dwordx4 v[228:231], v4, s[48:51], s6 offen sc1
    buffer_load_dwordx4 v[232:235], v5, s[48:51], s6 offen sc1
    buffer_load_dwordx4 v[236:239], v6, s[48:51], s6 offen sc1
    s_lshl2_add_u32 s6, s79, s11
    buffer_load_dwordx4 v[240:243], v3, s[48:51], s6 offen sc1
    buffer_load_dwordx4 v[244:247], v4, s[48:51], s6 offen sc1
    buffer_load_dwordx4 v[248:251], v5, s[48:51], s6 offen sc1
    buffer_load_dwordx4 v[252:255], v6, s[48:51], s6 offen sc1
    s_waitcnt vmcnt(12)
    s_lshl2_add_u32 s6, s80, s11
    v_mfma_f32_16x16x32_bf16 v[132:135], v[12:15], v[196:199], 0
    v_lshlrev_b32 v112, 16, v122
    v_and_b32 v113, 0xffff0000, v122
    v_mfma_f32_16x16x32_bf16 v[136:139], v[16:19], v[196:199], 0
    v_lshlrev_b32 v114, 16, v123
    v_and_b32 v115, 0xffff0000, v123
    v_mfma_f32_16x16x32_bf16 v[140:143], v[20:23], v[196:199], 0
    v_lshlrev_b32 v116, 16, v124
    v_and_b32 v117, 0xffff0000, v124
    v_mfma_f32_16x16x32_bf16 v[144:147], v[24:27], v[196:199], 0
    v_lshlrev_b32 v118, 16, v125
    v_and_b32 v119, 0xffff0000, v125
    v_mfma_f32_16x16x32_bf16 v[148:151], v[28:31], v[196:199], 0
    v_lshlrev_b32 v120, 16, v126
    v_and_b32 v121, 0xffff0000, v126
    buffer_load_dwordx4 v[196:199], v4, s[48:51], s6 offen sc1
    v_mfma_f32_16x16x32_bf16 v[152:155], v[12:15], v[200:203], 0
    v_lshlrev_b32 v122, 16, v127
    v_and_b32 v123, 0xffff0000, v127
    v_mfma_f32_16x16x32_bf16 v[156:159], v[16:19], v[200:203], 0
    v_lshlrev_b32 v124, 16, v128
    v_and_b32 v125, 0xffff0000, v128
    v_mfma_f32_16x16x32_bf16 v[160:163], v[20:23], v[200:203], 0
    v_lshlrev_b32 v126, 16, v129
    v_and_b32 v127, 0xffff0000, v129
    v_mfma_f32_16x16x32_bf16 v[164:167], v[24:27], v[200:203], 0
    v_lshlrev_b32 v128, 16, v130
    v_and_b32 v129, 0xffff0000, v130
    v_mfma_f32_16x16x32_bf16 v[168:171], v[28:31], v[200:203], 0
    v_lshlrev_b32 v130, 16, v131
    v_and_b32 v131, 0xffff0000, v131
    buffer_load_dwordx4 v[200:203], v5, s[48:51], s6 offen sc1
    v_mfma_f32_16x16x32_bf16 v[172:175], v[12:15], v[204:207], 0
    v_mfma_f32_16x16x32_bf16 v[176:179], v[16:19], v[204:207], 0
    v_mfma_f32_16x16x32_bf16 v[180:183], v[20:23], v[204:207], 0
    v_mfma_f32_16x16x32_bf16 v[184:187], v[24:27], v[204:207], 0
    v_mfma_f32_16x16x32_bf16 v[188:191], v[28:31], v[204:207], 0
    buffer_load_dwordx4 v[204:207], v6, s[48:51], s6 offen sc1
    v_mfma_f32_16x16x32_bf16 v[112:115], v[12:15], v[192:195], v[112:115]
    v_mfma_f32_16x16x32_bf16 v[116:119], v[16:19], v[192:195], v[116:119]
    v_mfma_f32_16x16x32_bf16 v[120:123], v[20:23], v[192:195], v[120:123]
    v_mfma_f32_16x16x32_bf16 v[124:127], v[24:27], v[192:195], v[124:127]
    v_mfma_f32_16x16x32_bf16 v[128:131], v[28:31], v[192:195], v[128:131]
    buffer_load_dwordx4 v[192:195], v3, s[48:51], s6 offen sc1
    s_waitcnt vmcnt(12)
    v_mfma_f32_16x16x32_bf16 v[112:115], v[32:35], v[208:211], v[112:115]
    s_mul_i32 s6, s3, 15360
    v_add_u32 v2, s6, v1
    v_mfma_f32_16x16x32_bf16 v[116:119], v[36:39], v[208:211], v[116:119]
    ds_read_b128 v[12:15], v2 offset:0
    v_mfma_f32_16x16x32_bf16 v[120:123], v[40:43], v[208:211], v[120:123]
    ds_read_b128 v[16:19], v2 offset:1024
    v_mfma_f32_16x16x32_bf16 v[124:127], v[44:47], v[208:211], v[124:127]
    ds_read_b128 v[20:23], v2 offset:2048
    v_mfma_f32_16x16x32_bf16 v[128:131], v[48:51], v[208:211], v[128:131]
    ds_read_b128 v[24:27], v2 offset:3072
    s_lshl2_add_u32 s6, s81, s11
    buffer_load_dwordx4 v[208:211], v3, s[48:51], s6 offen sc1
    v_mfma_f32_16x16x32_bf16 v[132:135], v[32:35], v[212:215], v[132:135]
    ds_read_b128 v[28:31], v2 offset:4096
    v_mfma_f32_16x16x32_bf16 v[136:139], v[36:39], v[212:215], v[136:139]
    v_mfma_f32_16x16x32_bf16 v[140:143], v[40:43], v[212:215], v[140:143]
    v_mfma_f32_16x16x32_bf16 v[144:147], v[44:47], v[212:215], v[144:147]
    v_mfma_f32_16x16x32_bf16 v[148:151], v[48:51], v[212:215], v[148:151]
    buffer_load_dwordx4 v[212:215], v4, s[48:51], s6 offen sc1
    v_mfma_f32_16x16x32_bf16 v[152:155], v[32:35], v[216:219], v[152:155]
    v_mfma_f32_16x16x32_bf16 v[156:159], v[36:39], v[216:219], v[156:159]
    v_mfma_f32_16x16x32_bf16 v[160:163], v[40:43], v[216:219], v[160:163]
    v_mfma_f32_16x16x32_bf16 v[164:167], v[44:47], v[216:219], v[164:167]
    v_mfma_f32_16x16x32_bf16 v[168:171], v[48:51], v[216:219], v[168:171]
    buffer_load_dwordx4 v[216:219], v5, s[48:51], s6 offen sc1
    v_mfma_f32_16x16x32_bf16 v[172:175], v[32:35], v[220:223], v[172:175]
    v_mfma_f32_16x16x32_bf16 v[176:179], v[36:39], v[220:223], v[176:179]
    v_mfma_f32_16x16x32_bf16 v[180:183], v[40:43], v[220:223], v[180:183]
    v_mfma_f32_16x16x32_bf16 v[184:187], v[44:47], v[220:223], v[184:187]
    v_mfma_f32_16x16x32_bf16 v[188:191], v[48:51], v[220:223], v[188:191]
    buffer_load_dwordx4 v[220:223], v6, s[48:51], s6 offen sc1
    s_waitcnt vmcnt(12)
    v_mfma_f32_16x16x32_bf16 v[112:115], v[52:55], v[224:227], v[112:115]
    v_mfma_f32_16x16x32_bf16 v[116:119], v[56:59], v[224:227], v[116:119]
    ds_read_b128 v[32:35], v2 offset:5120
    v_mfma_f32_16x16x32_bf16 v[120:123], v[60:63], v[224:227], v[120:123]
    ds_read_b128 v[36:39], v2 offset:6144
    v_mfma_f32_16x16x32_bf16 v[124:127], v[64:67], v[224:227], v[124:127]
    ds_read_b128 v[40:43], v2 offset:7168
    v_mfma_f32_16x16x32_bf16 v[128:131], v[68:71], v[224:227], v[128:131]
    ds_read_b128 v[44:47], v2 offset:8192
    s_lshl2_add_u32 s6, s82, s11
    buffer_load_dwordx4 v[224:227], v3, s[48:51], s6 offen sc1
    v_mfma_f32_16x16x32_bf16 v[132:135], v[52:55], v[228:231], v[132:135]
    ds_read_b128 v[48:51], v2 offset:9216
    v_mfma_f32_16x16x32_bf16 v[136:139], v[56:59], v[228:231], v[136:139]
    v_mfma_f32_16x16x32_bf16 v[140:143], v[60:63], v[228:231], v[140:143]
    v_mfma_f32_16x16x32_bf16 v[144:147], v[64:67], v[228:231], v[144:147]
    v_mfma_f32_16x16x32_bf16 v[148:151], v[68:71], v[228:231], v[148:151]
    buffer_load_dwordx4 v[228:231], v4, s[48:51], s6 offen sc1
    v_mfma_f32_16x16x32_bf16 v[152:155], v[52:55], v[232:235], v[152:155]
    v_mfma_f32_16x16x32_bf16 v[156:159], v[56:59], v[232:235], v[156:159]
    v_mfma_f32_16x16x32_bf16 v[160:163], v[60:63], v[232:235], v[160:163]
    v_mfma_f32_16x16x32_bf16 v[164:167], v[64:67], v[232:235], v[164:167]
    v_mfma_f32_16x16x32_bf16 v[168:171], v[68:71], v[232:235], v[168:171]
    buffer_load_dwordx4 v[232:235], v5, s[48:51], s6 offen sc1
    v_mfma_f32_16x16x32_bf16 v[172:175], v[52:55], v[236:239], v[172:175]
    v_mfma_f32_16x16x32_bf16 v[176:179], v[56:59], v[236:239], v[176:179]
    v_mfma_f32_16x16x32_bf16 v[180:183], v[60:63], v[236:239], v[180:183]
    v_mfma_f32_16x16x32_bf16 v[184:187], v[64:67], v[236:239], v[184:187]
    v_mfma_f32_16x16x32_bf16 v[188:191], v[68:71], v[236:239], v[188:191]
    buffer_load_dwordx4 v[236:239], v6, s[48:51], s6 offen sc1
    s_waitcnt vmcnt(12)
    v_mfma_f32_16x16x32_bf16 v[112:115], v[72:75], v[240:243], v[112:115]
    v_mfma_f32_16x16x32_bf16 v[116:119], v[76:79], v[240:243], v[116:119]
    ds_read_b128 v[52:55], v2 offset:10240
    v_mfma_f32_16x16x32_bf16 v[120:123], v[80:83], v[240:243], v[120:123]
    ds_read_b128 v[56:59], v2 offset:11264
    v_mfma_f32_16x16x32_bf16 v[124:127], v[84:87], v[240:243], v[124:127]
    ds_read_b128 v[60:63], v2 offset:12288
    v_mfma_f32_16x16x32_bf16 v[128:131], v[88:91], v[240:243], v[128:131]
    ds_read_b128 v[64:67], v2 offset:13312
    s_lshl2_add_u32 s6, s83, s11
    buffer_load_dwordx4 v[240:243], v3, s[48:51], s6 offen sc1
    v_mfma_f32_16x16x32_bf16 v[132:135], v[72:75], v[244:247], v[132:135]
    ds_read_b128 v[68:71], v2 offset:14336
    v_mfma_f32_16x16x32_bf16 v[136:139], v[76:79], v[244:247], v[136:139]
    v_mfma_f32_16x16x32_bf16 v[140:143], v[80:83], v[244:247], v[140:143]
    v_mfma_f32_16x16x32_bf16 v[144:147], v[84:87], v[244:247], v[144:147]
    v_mfma_f32_16x16x32_bf16 v[148:151], v[88:91], v[244:247], v[148:151]
    buffer_load_dwordx4 v[244:247], v4, s[48:51], s6 offen sc1
    v_mfma_f32_16x16x32_bf16 v[152:155], v[72:75], v[248:251], v[152:155]
    v_mfma_f32_16x16x32_bf16 v[156:159], v[76:79], v[248:251], v[156:159]
    v_mfma_f32_16x16x32_bf16 v[160:163], v[80:83], v[248:251], v[160:163]
    v_mfma_f32_16x16x32_bf16 v[164:167], v[84:87], v[248:251], v[164:167]
    v_mfma_f32_16x16x32_bf16 v[168:171], v[88:91], v[248:251], v[168:171]
    buffer_load_dwordx4 v[248:251], v5, s[48:51], s6 offen sc1
    v_mfma_f32_16x16x32_bf16 v[172:175], v[72:75], v[252:255], v[172:175]
    v_mfma_f32_16x16x32_bf16 v[176:179], v[76:79], v[252:255], v[176:179]
    v_mfma_f32_16x16x32_bf16 v[180:183], v[80:83], v[252:255], v[180:183]
    v_mfma_f32_16x16x32_bf16 v[184:187], v[84:87], v[252:255], v[184:187]
    v_mfma_f32_16x16x32_bf16 v[188:191], v[88:91], v[252:255], v[188:191]
    buffer_load_dwordx4 v[252:255], v6, s[48:51], s6 offen sc1
    s_waitcnt vmcnt(12)
    v_mfma_f32_16x16x32_bf16 v[112:115], v[92:95], v[192:195], v[112:115]
    v_mfma_f32_16x16x32_bf16 v[116:119], v[96:99], v[192:195], v[116:119]
    s_lshl2_add_u32 s0, s84, s10
    s_add_u32 s0, s0, s84
    buffer_load_dwordx4 v[72:75], v1, s[48:51], s0 offen offset:0 sc1
    v_mfma_f32_16x16x32_bf16 v[120:123], v[100:103], v[192:195], v[120:123]
    v_mfma_f32_16x16x32_bf16 v[124:127], v[104:107], v[192:195], v[124:127]
    buffer_load_dwordx4 v[76:79], v1, s[48:51], s0 offen offset:1024 sc1
    v_mfma_f32_16x16x32_bf16 v[128:131], v[108:111], v[192:195], v[128:131]
    s_lshl2_add_u32 s6, s84, s11
    buffer_load_dwordx4 v[192:195], v3, s[48:51], s6 offen sc1
    v_mfma_f32_16x16x32_bf16 v[132:135], v[92:95], v[196:199], v[132:135]
    v_mfma_f32_16x16x32_bf16 v[136:139], v[96:99], v[196:199], v[136:139]
    v_mfma_f32_16x16x32_bf16 v[140:143], v[100:103], v[196:199], v[140:143]
    buffer_load_dwordx4 v[80:83], v1, s[48:51], s0 offen offset:2048 sc1
    v_mfma_f32_16x16x32_bf16 v[144:147], v[104:107], v[196:199], v[144:147]
    v_mfma_f32_16x16x32_bf16 v[148:151], v[108:111], v[196:199], v[148:151]
    buffer_load_dwordx4 v[196:199], v4, s[48:51], s6 offen sc1
    v_mfma_f32_16x16x32_bf16 v[152:155], v[92:95], v[200:203], v[152:155]
    v_mfma_f32_16x16x32_bf16 v[156:159], v[96:99], v[200:203], v[156:159]
    buffer_load_dwordx4 v[84:87], v1, s[48:51], s0 offen offset:3072 sc1
    v_mfma_f32_16x16x32_bf16 v[160:163], v[100:103], v[200:203], v[160:163]
    v_mfma_f32_16x16x32_bf16 v[164:167], v[104:107], v[200:203], v[164:167]
    v_mfma_f32_16x16x32_bf16 v[168:171], v[108:111], v[200:203], v[168:171]
    buffer_load_dwordx4 v[200:203], v5, s[48:51], s6 offen sc1
    v_mfma_f32_16x16x32_bf16 v[172:175], v[92:95], v[204:207], v[172:175]
    v_mfma_f32_16x16x32_bf16 v[176:179], v[96:99], v[204:207], v[176:179]
    s_add_u32 s0, s0, 4096
    buffer_load_dwordx4 v[88:91], v1, s[48:51], s0 offen offset:0 sc1
    v_mfma_f32_16x16x32_bf16 v[180:183], v[100:103], v[204:207], v[180:183]
    v_mfma_f32_16x16x32_bf16 v[184:187], v[104:107], v[204:207], v[184:187]
    v_mfma_f32_16x16x32_bf16 v[188:191], v[108:111], v[204:207], v[188:191]
    buffer_load_dwordx4 v[204:207], v6, s[48:51], s6 offen sc1
    s_waitcnt vmcnt(17)
    s_waitcnt lgkmcnt(10)
    v_mfma_f32_16x16x32_bf16 v[112:115], v[12:15], v[208:211], v[112:115]
    v_mfma_f32_16x16x32_bf16 v[116:119], v[16:19], v[208:211], v[116:119]
    s_lshl2_add_u32 s0, s85, s10
    s_add_u32 s0, s0, s85
    buffer_load_dwordx4 v[92:95], v1, s[48:51], s0 offen offset:0 sc1
    v_mfma_f32_16x16x32_bf16 v[120:123], v[20:23], v[208:211], v[120:123]
    v_mfma_f32_16x16x32_bf16 v[124:127], v[24:27], v[208:211], v[124:127]
    buffer_load_dwordx4 v[96:99], v1, s[48:51], s0 offen offset:1024 sc1
    v_mfma_f32_16x16x32_bf16 v[128:131], v[28:31], v[208:211], v[128:131]
    s_lshl2_add_u32 s6, s85, s11
    buffer_load_dwordx4 v[208:211], v3, s[48:51], s6 offen sc1
    v_mfma_f32_16x16x32_bf16 v[132:135], v[12:15], v[212:215], v[132:135]
    v_mfma_f32_16x16x32_bf16 v[136:139], v[16:19], v[212:215], v[136:139]
    v_mfma_f32_16x16x32_bf16 v[140:143], v[20:23], v[212:215], v[140:143]
    buffer_load_dwordx4 v[100:103], v1, s[48:51], s0 offen offset:2048 sc1
    v_mfma_f32_16x16x32_bf16 v[144:147], v[24:27], v[212:215], v[144:147]
    v_mfma_f32_16x16x32_bf16 v[148:151], v[28:31], v[212:215], v[148:151]
    buffer_load_dwordx4 v[212:215], v4, s[48:51], s6 offen sc1
    v_mfma_f32_16x16x32_bf16 v[152:155], v[12:15], v[216:219], v[152:155]
    v_mfma_f32_16x16x32_bf16 v[156:159], v[16:19], v[216:219], v[156:159]
    buffer_load_dwordx4 v[104:107], v1, s[48:51], s0 offen offset:3072 sc1
    v_mfma_f32_16x16x32_bf16 v[160:163], v[20:23], v[216:219], v[160:163]
    v_mfma_f32_16x16x32_bf16 v[164:167], v[24:27], v[216:219], v[164:167]
    v_mfma_f32_16x16x32_bf16 v[168:171], v[28:31], v[216:219], v[168:171]
    buffer_load_dwordx4 v[216:219], v5, s[48:51], s6 offen sc1
    v_mfma_f32_16x16x32_bf16 v[172:175], v[12:15], v[220:223], v[172:175]
    v_mfma_f32_16x16x32_bf16 v[176:179], v[16:19], v[220:223], v[176:179]
    s_add_u32 s0, s0, 4096
    buffer_load_dwordx4 v[108:111], v1, s[48:51], s0 offen offset:0 sc1
    v_mfma_f32_16x16x32_bf16 v[180:183], v[20:23], v[220:223], v[180:183]
    v_mfma_f32_16x16x32_bf16 v[184:187], v[24:27], v[220:223], v[184:187]
    v_mfma_f32_16x16x32_bf16 v[188:191], v[28:31], v[220:223], v[188:191]
    buffer_load_dwordx4 v[220:223], v6, s[48:51], s6 offen sc1
    s_waitcnt vmcnt(22)
    s_waitcnt lgkmcnt(5)
    v_mfma_f32_16x16x32_bf16 v[112:115], v[32:35], v[224:227], v[112:115]
    v_mfma_f32_16x16x32_bf16 v[116:119], v[36:39], v[224:227], v[116:119]
    s_lshl2_add_u32 s0, s86, s10
    s_add_u32 s0, s0, s86
    buffer_load_dwordx4 v[12:15], v1, s[48:51], s0 offen offset:0 sc1
    v_mfma_f32_16x16x32_bf16 v[120:123], v[40:43], v[224:227], v[120:123]
    v_mfma_f32_16x16x32_bf16 v[124:127], v[44:47], v[224:227], v[124:127]
    buffer_load_dwordx4 v[16:19], v1, s[48:51], s0 offen offset:1024 sc1
    v_mfma_f32_16x16x32_bf16 v[128:131], v[48:51], v[224:227], v[128:131]
    s_lshl2_add_u32 s6, s86, s11
    buffer_load_dwordx4 v[224:227], v3, s[48:51], s6 offen sc1
    v_mfma_f32_16x16x32_bf16 v[132:135], v[32:35], v[228:231], v[132:135]
    v_mfma_f32_16x16x32_bf16 v[136:139], v[36:39], v[228:231], v[136:139]
    v_mfma_f32_16x16x32_bf16 v[140:143], v[40:43], v[228:231], v[140:143]
    buffer_load_dwordx4 v[20:23], v1, s[48:51], s0 offen offset:2048 sc1
    v_mfma_f32_16x16x32_bf16 v[144:147], v[44:47], v[228:231], v[144:147]
    v_mfma_f32_16x16x32_bf16 v[148:151], v[48:51], v[228:231], v[148:151]
    buffer_load_dwordx4 v[228:231], v4, s[48:51], s6 offen sc1
    v_mfma_f32_16x16x32_bf16 v[152:155], v[32:35], v[232:235], v[152:155]
    v_mfma_f32_16x16x32_bf16 v[156:159], v[36:39], v[232:235], v[156:159]
    buffer_load_dwordx4 v[24:27], v1, s[48:51], s0 offen offset:3072 sc1
    v_mfma_f32_16x16x32_bf16 v[160:163], v[40:43], v[232:235], v[160:163]
    v_mfma_f32_16x16x32_bf16 v[164:167], v[44:47], v[232:235], v[164:167]
    v_mfma_f32_16x16x32_bf16 v[168:171], v[48:51], v[232:235], v[168:171]
    buffer_load_dwordx4 v[232:235], v5, s[48:51], s6 offen sc1
    v_mfma_f32_16x16x32_bf16 v[172:175], v[32:35], v[236:239], v[172:175]
    v_mfma_f32_16x16x32_bf16 v[176:179], v[36:39], v[236:239], v[176:179]
    s_add_u32 s0, s0, 4096
    buffer_load_dwordx4 v[28:31], v1, s[48:51], s0 offen offset:0 sc1
    v_mfma_f32_16x16x32_bf16 v[180:183], v[40:43], v[236:239], v[180:183]
    v_mfma_f32_16x16x32_bf16 v[184:187], v[44:47], v[236:239], v[184:187]
    v_mfma_f32_16x16x32_bf16 v[188:191], v[48:51], v[236:239], v[188:191]
    buffer_load_dwordx4 v[236:239], v6, s[48:51], s6 offen sc1
    s_waitcnt vmcnt(27)
    s_waitcnt lgkmcnt(0)
    v_add_u32 v11, 1, v11
    ds_write_b32 v9, v11
    v_mfma_f32_16x16x32_bf16 v[112:115], v[52:55], v[240:243], v[112:115]
    v_mfma_f32_16x16x32_bf16 v[116:119], v[56:59], v[240:243], v[116:119]
    s_lshl2_add_u32 s0, s87, s10
    s_add_u32 s0, s0, s87
    buffer_load_dwordx4 v[32:35], v1, s[48:51], s0 offen offset:0 sc1
    v_mfma_f32_16x16x32_bf16 v[120:123], v[60:63], v[240:243], v[120:123]
    v_mfma_f32_16x16x32_bf16 v[124:127], v[64:67], v[240:243], v[124:127]
    buffer_load_dwordx4 v[36:39], v1, s[48:51], s0 offen offset:1024 sc1
    v_mfma_f32_16x16x32_bf16 v[128:131], v[68:71], v[240:243], v[128:131]
    s_lshl2_add_u32 s6, s87, s11
    buffer_load_dwordx4 v[240:243], v3, s[48:51], s6 offen sc1
    v_mfma_f32_16x16x32_bf16 v[132:135], v[52:55], v[244:247], v[132:135]
    v_mfma_f32_16x16x32_bf16 v[136:139], v[56:59], v[244:247], v[136:139]
    v_mfma_f32_16x16x32_bf16 v[140:143], v[60:63], v[244:247], v[140:143]
    buffer_load_dwordx4 v[40:43], v1, s[48:51], s0 offen offset:2048 sc1
    v_mfma_f32_16x16x32_bf16 v[144:147], v[64:67], v[244:247], v[144:147]
    v_mfma_f32_16x16x32_bf16 v[148:151], v[68:71], v[244:247], v[148:151]
    buffer_load_dwordx4 v[244:247], v4, s[48:51], s6 offen sc1
    v_mfma_f32_16x16x32_bf16 v[152:155], v[52:55], v[248:251], v[152:155]
    v_mfma_f32_16x16x32_bf16 v[156:159], v[56:59], v[248:251], v[156:159]
    buffer_load_dwordx4 v[44:47], v1, s[48:51], s0 offen offset:3072 sc1
    v_mfma_f32_16x16x32_bf16 v[160:163], v[60:63], v[248:251], v[160:163]
    v_mfma_f32_16x16x32_bf16 v[164:167], v[64:67], v[248:251], v[164:167]
    v_mfma_f32_16x16x32_bf16 v[168:171], v[68:71], v[248:251], v[168:171]
    buffer_load_dwordx4 v[248:251], v5, s[48:51], s6 offen sc1
    v_mfma_f32_16x16x32_bf16 v[172:175], v[52:55], v[252:255], v[172:175]
    v_mfma_f32_16x16x32_bf16 v[176:179], v[56:59], v[252:255], v[176:179]
    s_add_u32 s0, s0, 4096
    buffer_load_dwordx4 v[48:51], v1, s[48:51], s0 offen offset:0 sc1
    v_mfma_f32_16x16x32_bf16 v[180:183], v[60:63], v[252:255], v[180:183]
    v_mfma_f32_16x16x32_bf16 v[184:187], v[64:67], v[252:255], v[184:187]
    v_mfma_f32_16x16x32_bf16 v[188:191], v[68:71], v[252:255], v[188:191]
    buffer_load_dwordx4 v[252:255], v6, s[48:51], s6 offen sc1
    s_waitcnt vmcnt(27)
    v_mfma_f32_16x16x32_bf16 v[112:115], v[72:75], v[192:195], v[112:115]
    v_mfma_f32_16x16x32_bf16 v[116:119], v[76:79], v[192:195], v[116:119]
    s_lshl2_add_u32 s0, s88, s10
    s_add_u32 s0, s0, s88
    buffer_load_dwordx4 v[52:55], v1, s[48:51], s0 offen offset:0 sc1
    v_mfma_f32_16x16x32_bf16 v[120:123], v[80:83], v[192:195], v[120:123]
    v_mfma_f32_16x16x32_bf16 v[124:127], v[84:87], v[192:195], v[124:127]
    buffer_load_dwordx4 v[56:59], v1, s[48:51], s0 offen offset:1024 sc1
    v_mfma_f32_16x16x32_bf16 v[128:131], v[88:91], v[192:195], v[128:131]
    s_lshl2_add_u32 s6, s88, s11
    buffer_load_dwordx4 v[192:195], v3, s[48:51], s6 offen sc1
    v_mfma_f32_16x16x32_bf16 v[132:135], v[72:75], v[196:199], v[132:135]
    v_mfma_f32_16x16x32_bf16 v[136:139], v[76:79], v[196:199], v[136:139]
    v_mfma_f32_16x16x32_bf16 v[140:143], v[80:83], v[196:199], v[140:143]
    buffer_load_dwordx4 v[60:63], v1, s[48:51], s0 offen offset:2048 sc1
    v_mfma_f32_16x16x32_bf16 v[144:147], v[84:87], v[196:199], v[144:147]
    v_mfma_f32_16x16x32_bf16 v[148:151], v[88:91], v[196:199], v[148:151]
    buffer_load_dwordx4 v[196:199], v4, s[48:51], s6 offen sc1
    v_mfma_f32_16x16x32_bf16 v[152:155], v[72:75], v[200:203], v[152:155]
    v_mfma_f32_16x16x32_bf16 v[156:159], v[76:79], v[200:203], v[156:159]
    buffer_load_dwordx4 v[64:67], v1, s[48:51], s0 offen offset:3072 sc1
    v_mfma_f32_16x16x32_bf16 v[160:163], v[80:83], v[200:203], v[160:163]
    v_mfma_f32_16x16x32_bf16 v[164:167], v[84:87], v[200:203], v[164:167]
    v_mfma_f32_16x16x32_bf16 v[168:171], v[88:91], v[200:203], v[168:171]
    buffer_load_dwordx4 v[200:203], v5, s[48:51], s6 offen sc1
    v_mfma_f32_16x16x32_bf16 v[172:175], v[72:75], v[204:207], v[172:175]
    v_mfma_f32_16x16x32_bf16 v[176:179], v[76:79], v[204:207], v[176:179]
    s_add_u32 s0, s0, 4096
    buffer_load_dwordx4 v[68:71], v1, s[48:51], s0 offen offset:0 sc1
    v_mfma_f32_16x16x32_bf16 v[180:183], v[80:83], v[204:207], v[180:183]
    v_mfma_f32_16x16x32_bf16 v[184:187], v[84:87], v[204:207], v[184:187]
    v_mfma_f32_16x16x32_bf16 v[188:191], v[88:91], v[204:207], v[188:191]
    buffer_load_dwordx4 v[204:207], v6, s[48:51], s6 offen sc1
    s_waitcnt vmcnt(27)
    v_mfma_f32_16x16x32_bf16 v[112:115], v[92:95], v[208:211], v[112:115]
    v_mfma_f32_16x16x32_bf16 v[116:119], v[96:99], v[208:211], v[116:119]
    s_mov_b64 exec, s[24:25]
    s_lshl2_add_u32 s0, s89, s10
    s_add_u32 s0, s0, s89
    buffer_load_dwordx4 v[72:75], v1, s[48:51], s0 offen offset:0 sc1
    s_mov_b64 exec, -1
    v_mfma_f32_16x16x32_bf16 v[120:123], v[100:103], v[208:211], v[120:123]
    v_mfma_f32_16x16x32_bf16 v[124:127], v[104:107], v[208:211], v[124:127]
    s_mov_b64 exec, s[24:25]
    buffer_load_dwordx4 v[76:79], v1, s[48:51], s0 offen offset:1024 sc1
    s_mov_b64 exec, -1
    v_mfma_f32_16x16x32_bf16 v[128:131], v[108:111], v[208:211], v[128:131]
    s_mov_b64 exec, s[24:25]
    s_lshl2_add_u32 s6, s89, s11
    buffer_load_dwordx4 v[208:211], v3, s[48:51], s6 offen sc1
    s_mov_b64 exec, -1
    v_mfma_f32_16x16x32_bf16 v[132:135], v[92:95], v[212:215], v[132:135]
    v_mfma_f32_16x16x32_bf16 v[136:139], v[96:99], v[212:215], v[136:139]
    v_mfma_f32_16x16x32_bf16 v[140:143], v[100:103], v[212:215], v[140:143]
    s_mov_b64 exec, s[24:25]
    buffer_load_dwordx4 v[80:83], v1, s[48:51], s0 offen offset:2048 sc1
    s_mov_b64 exec, -1
    v_mfma_f32_16x16x32_bf16 v[144:147], v[104:107], v[212:215], v[144:147]
    v_mfma_f32_16x16x32_bf16 v[148:151], v[108:111], v[212:215], v[148:151]
    s_mov_b64 exec, s[24:25]
    buffer_load_dwordx4 v[212:215], v4, s[48:51], s6 offen sc1
    s_mov_b64 exec, -1
    v_mfma_f32_16x16x32_bf16 v[152:155], v[92:95], v[216:219], v[152:155]
    v_mfma_f32_16x16x32_bf16 v[156:159], v[96:99], v[216:219], v[156:159]
    s_mov_b64 exec, s[24:25]
    buffer_load_dwordx4 v[84:87], v1, s[48:51], s0 offen offset:3072 sc1
    s_mov_b64 exec, -1
    v_mfma_f32_16x16x32_bf16 v[160:163], v[100:103], v[216:219], v[160:163]
    v_mfma_f32_16x16x32_bf16 v[164:167], v[104:107], v[216:219], v[164:167]
    v_mfma_f32_16x16x32_bf16 v[168:171], v[108:111], v[216:219], v[168:171]
    s_mov_b64 exec, s[24:25]
    buffer_load_dwordx4 v[216:219], v5, s[48:51], s6 offen sc1
    s_mov_b64 exec, -1
    v_mfma_f32_16x16x32_bf16 v[172:175], v[92:95], v[220:223], v[172:175]
    v_mfma_f32_16x16x32_bf16 v[176:179], v[96:99], v[220:223], v[176:179]
    s_mov_b64 exec, s[24:25]
    s_add_u32 s0, s0, 4096
    buffer_load_dwordx4 v[88:91], v1, s[48:51], s0 offen offset:0 sc1
    s_mov_b64 exec, -1
    v_mfma_f32_16x16x32_bf16 v[180:183], v[100:103], v[220:223], v[180:183]
    v_mfma_f32_16x16x32_bf16 v[184:187], v[104:107], v[220:223], v[184:187]
    v_mfma_f32_16x16x32_bf16 v[188:191], v[108:111], v[220:223], v[188:191]
    s_mov_b64 exec, s[24:25]
    buffer_load_dwordx4 v[220:223], v6, s[48:51], s6 offen sc1
    s_mov_b64 exec, -1
    s_waitcnt vmcnt(27)
    v_mfma_f32_16x16x32_bf16 v[112:115], v[12:15], v[224:227], v[112:115]
    v_mfma_f32_16x16x32_bf16 v[116:119], v[16:19], v[224:227], v[116:119]
    v_mov_b32 v2, 99588
    v_mfma_f32_16x16x32_bf16 v[120:123], v[20:23], v[224:227], v[120:123]
    ds_read_b32 v8, v2
    v_mfma_f32_16x16x32_bf16 v[124:127], v[24:27], v[224:227], v[124:127]
    v_lshrrev_b32 v98, 1, v0
    v_mfma_f32_16x16x32_bf16 v[128:131], v[28:31], v[224:227], v[128:131]
    v_and_b32 v4, 1, v0
    v_mfma_f32_16x16x32_bf16 v[132:135], v[12:15], v[228:231], v[132:135]
    v_lshlrev_b32 v98, 12, v98
    v_mfma_f32_16x16x32_bf16 v[136:139], v[16:19], v[228:231], v[136:139]
    v_lshl_add_u32 v98, v4, 4, v98
    v_mfma_f32_16x16x32_bf16 v[140:143], v[20:23], v[228:231], v[140:143]
    s_mul_i32 s44, s14, 327680
    s_lshl_b32 s7, s13, 7
    v_mfma_f32_16x16x32_bf16 v[144:147], v[24:27], v[228:231], v[144:147]
    s_add_u32 s44, s44, s7
    s_lshl_b32 s7, s3, 5
    v_mfma_f32_16x16x32_bf16 v[148:151], v[28:31], v[228:231], v[148:151]
    s_add_u32 s44, s44, s7
    s_add_u32 s44, s44, 13631488
    v_mfma_f32_16x16x32_bf16 v[152:155], v[12:15], v[232:235], v[152:155]
    s_lshl_b32 s6, s13, 6
    s_lshl_b32 s7, s3, 4
    v_mfma_f32_16x16x32_bf16 v[156:159], v[16:19], v[232:235], v[156:159]
    s_add_u32 s6, s6, s7
    s_mul_i32 s6, s6, 1280
    v_mfma_f32_16x16x32_bf16 v[160:163], v[20:23], v[232:235], v[160:163]
    s_add_u32 s8, s8, s6
    s_mul_i32 s9, s3, 2560
    v_mfma_f32_16x16x32_bf16 v[164:167], v[24:27], v[232:235], v[164:167]
    s_add_u32 s9, s9, 152832
    s_movk_i32 s0, 1280
    s_movk_i32 s1, 160
    v_mfma_f32_16x16x32_bf16 v[168:171], v[28:31], v[232:235], v[168:171]
    v_mfma_f32_16x16x32_bf16 v[172:175], v[12:15], v[236:239], v[172:175]
    v_mfma_f32_16x16x32_bf16 v[176:179], v[16:19], v[236:239], v[176:179]
    v_mfma_f32_16x16x32_bf16 v[180:183], v[20:23], v[236:239], v[180:183]
    v_mfma_f32_16x16x32_bf16 v[184:187], v[24:27], v[236:239], v[184:187]
    v_mfma_f32_16x16x32_bf16 v[188:191], v[28:31], v[236:239], v[188:191]
    s_waitcnt lgkmcnt(0)
    v_cmp_gt_u32 s[42:43], 5, v8
    buffer_load_dwordx4 v[12:15], v98, s[48:51], s44 offen sc1
    s_add_u32 s6, s44, 131072
    buffer_load_dwordx4 v[16:19], v98, s[48:51], s6 offen sc1
    s_add_u32 s6, s44, 262144
    s_mov_b32 exec_hi, 0
    buffer_load_dwordx4 v[20:23], v98, s[48:51], s6 offen sc1
    s_mov_b64 exec, -1
    s_waitcnt vmcnt(21)
    v_mfma_f32_16x16x32_bf16 v[112:115], v[32:35], v[240:243], v[112:115]
    v_mfma_f32_16x16x32_bf16 v[116:119], v[36:39], v[240:243], v[116:119]
    v_add_u32 v3, 0, v0
    v_mul_u32_u24 v4, 6554, v3
    v_mfma_f32_16x16x32_bf16 v[120:123], v[40:43], v[240:243], v[120:123]
    v_lshrrev_b32 v4, 16, v4
    v_mul_u32_u24 v5, 10, v4
    v_mfma_f32_16x16x32_bf16 v[124:127], v[44:47], v[240:243], v[124:127]
    v_sub_u32 v3, v3, v5
    v_lshlrev_b32 v3, 4, v3
    v_mfma_f32_16x16x32_bf16 v[128:131], v[48:51], v[240:243], v[128:131]
    v_mad_u32_u24 v92, v4, s0, v3
    v_mad_u32_u24 v95, v4, s1, v3
    v_mfma_f32_16x16x32_bf16 v[132:135], v[32:35], v[244:247], v[132:135]
    v_add_u32 v95, s9, v95
    v_mfma_f32_16x16x32_bf16 v[136:139], v[36:39], v[244:247], v[136:139]
    v_add_u32 v3, 64, v0
    v_mul_u32_u24 v4, 6554, v3
    v_mfma_f32_16x16x32_bf16 v[140:143], v[40:43], v[244:247], v[140:143]
    v_lshrrev_b32 v4, 16, v4
    v_mul_u32_u24 v5, 10, v4
    v_mfma_f32_16x16x32_bf16 v[144:147], v[44:47], v[244:247], v[144:147]
    v_sub_u32 v3, v3, v5
    v_lshlrev_b32 v3, 4, v3
    v_mfma_f32_16x16x32_bf16 v[148:151], v[48:51], v[244:247], v[148:151]
    v_mad_u32_u24 v93, v4, s0, v3
    v_mad_u32_u24 v96, v4, s1, v3
    v_mfma_f32_16x16x32_bf16 v[152:155], v[32:35], v[248:251], v[152:155]
    v_add_u32 v96, s9, v96
    v_mfma_f32_16x16x32_bf16 v[156:159], v[36:39], v[248:251], v[156:159]
    v_add_u32 v3, 128, v0
    v_mul_u32_u24 v4, 6554, v3
    v_mfma_f32_16x16x32_bf16 v[160:163], v[40:43], v[248:251], v[160:163]
    v_lshrrev_b32 v4, 16, v4
    v_mul_u32_u24 v5, 10, v4
    v_mfma_f32_16x16x32_bf16 v[164:167], v[44:47], v[248:251], v[164:167]
    v_sub_u32 v3, v3, v5
    v_lshlrev_b32 v3, 4, v3
    v_mfma_f32_16x16x32_bf16 v[168:171], v[48:51], v[248:251], v[168:171]
    v_mad_u32_u24 v94, v4, s0, v3
    v_mad_u32_u24 v97, v4, s1, v3
    v_mfma_f32_16x16x32_bf16 v[172:175], v[32:35], v[252:255], v[172:175]
    v_add_u32 v97, s9, v97
    v_mfma_f32_16x16x32_bf16 v[176:179], v[36:39], v[252:255], v[176:179]
    v_mfma_f32_16x16x32_bf16 v[180:183], v[40:43], v[252:255], v[180:183]
    v_mfma_f32_16x16x32_bf16 v[184:187], v[44:47], v[252:255], v[184:187]
    v_mfma_f32_16x16x32_bf16 v[188:191], v[48:51], v[252:255], v[188:191]
    s_waitcnt vmcnt(12)
    v_mfma_f32_16x16x32_bf16 v[112:115], v[52:55], v[192:195], v[112:115]
    ds_read_b32 v26, v10
    v_mfma_f32_16x16x32_bf16 v[116:119], v[56:59], v[192:195], v[116:119]
    buffer_load_dwordx4 v[32:35], v92, s[52:55], s8 offen
    v_mfma_f32_16x16x32_bf16 v[120:123], v[60:63], v[192:195], v[120:123]
    v_mfma_f32_16x16x32_bf16 v[124:127], v[64:67], v[192:195], v[124:127]
    buffer_load_dwordx4 v[36:39], v93, s[52:55], s8 offen
    v_mfma_f32_16x16x32_bf16 v[128:131], v[68:71], v[192:195], v[128:131]
    v_mfma_f32_16x16x32_bf16 v[132:135], v[52:55], v[196:199], v[132:135]
    s_mov_b32 exec_hi, 0
    buffer_load_dwordx4 v[40:43], v94, s[52:55], s8 offen
    s_mov_b64 exec, -1
    v_mfma_f32_16x16x32_bf16 v[136:139], v[56:59], v[196:199], v[136:139]
    s_xor_b32 s6, s3, 1
    s_mul_i32 s6, s6, 15360
    v_mfma_f32_16x16x32_bf16 v[140:143], v[60:63], v[196:199], v[140:143]
    s_add_u32 s6, s6, 0
    v_add_u32 v99, s6, v1
    v_mfma_f32_16x16x32_bf16 v[144:147], v[64:67], v[196:199], v[144:147]
    s_xor_b32 s6, s3, 2
    s_mul_i32 s6, s6, 15360
    v_mfma_f32_16x16x32_bf16 v[148:151], v[68:71], v[196:199], v[148:151]
    s_add_u32 s6, s6, 5120
    v_add_u32 v100, s6, v1
    v_mfma_f32_16x16x32_bf16 v[152:155], v[52:55], v[200:203], v[152:155]
    s_xor_b32 s6, s3, 3
    s_mul_i32 s6, s6, 15360
    v_mfma_f32_16x16x32_bf16 v[156:159], v[56:59], v[200:203], v[156:159]
    s_add_u32 s6, s6, 10240
    v_add_u32 v101, s6, v1
    v_mfma_f32_16x16x32_bf16 v[160:163], v[60:63], v[200:203], v[160:163]
    s_mul_i32 s6, s3, 15360
    v_add_u32 v102, s6, v1
    v_mfma_f32_16x16x32_bf16 v[164:167], v[64:67], v[200:203], v[164:167]
    v_and_b32 v3, 15, v0
    v_mul_u32_u24 v3, 160, v3
    v_mfma_f32_16x16x32_bf16 v[168:171], v[68:71], v[200:203], v[168:171]
    v_lshrrev_b32 v5, 4, v0
    v_lshl_add_u32 v3, v5, 3, v3
    v_mfma_f32_16x16x32_bf16 v[172:175], v[52:55], v[204:207], v[172:175]
    v_add_u32 v103, s9, v3
    v_mfma_f32_16x16x32_bf16 v[176:179], v[56:59], v[204:207], v[176:179]
    v_add_u32 v3, s9, v1
    v_lshlrev_b32 v4, 3, v0
    v_mfma_f32_16x16x32_bf16 v[180:183], v[60:63], v[204:207], v[180:183]
    v_add_u32 v4, s9, v4
    v_mfma_f32_16x16x32_bf16 v[184:187], v[64:67], v[204:207], v[184:187]
    v_mfma_f32_16x16x32_bf16 v[188:191], v[68:71], v[204:207], v[188:191]
    s_waitcnt lgkmcnt(0)
    v_cmp_gt_u32 vcc, v11, v26
    s_nop 0
    s_cbranch_vccnz SPIN_29
BACK_30:
    s_cmp_ge_u32 s3, 2
    s_cbranch_scc1 L_SKIP13
    s_waitcnt vmcnt(6)
    v_mfma_f32_16x16x32_bf16 v[132:135], v[72:75], v[212:215], v[132:135]
    v_mfma_f32_16x16x32_bf16 v[136:139], v[76:79], v[212:215], v[136:139]
    v_mfma_f32_16x16x32_bf16 v[140:143], v[80:83], v[212:215], v[140:143]
    v_mfma_f32_16x16x32_bf16 v[144:147], v[84:87], v[212:215], v[144:147]
    v_mfma_f32_16x16x32_bf16 v[148:151], v[88:91], v[212:215], v[148:151]
    v_mfma_f32_16x16x32_bf16 v[152:155], v[72:75], v[216:219], v[152:155]
    v_mfma_f32_16x16x32_bf16 v[156:159], v[76:79], v[216:219], v[156:159]
    v_mfma_f32_16x16x32_bf16 v[160:163], v[80:83], v[216:219], v[160:163]
    v_mfma_f32_16x16x32_bf16 v[164:167], v[84:87], v[216:219], v[164:167]
    v_mfma_f32_16x16x32_bf16 v[168:171], v[88:91], v[216:219], v[168:171]
    ds_write_b128 v99, v[132:135] offset:0
    v_mfma_f32_16x16x32_bf16 v[172:175], v[72:75], v[220:223], v[172:175]
    ds_write_b128 v99, v[136:139] offset:1024
    v_mfma_f32_16x16x32_bf16 v[176:179], v[76:79], v[220:223], v[176:179]
    ds_write_b128 v99, v[140:143] offset:2048
    v_mfma_f32_16x16x32_bf16 v[180:183], v[80:83], v[220:223], v[180:183]
    ds_write_b128 v99, v[144:147] offset:3072
    v_mfma_f32_16x16x32_bf16 v[184:187], v[84:87], v[220:223], v[184:187]
    ds_write_b128 v99, v[148:151] offset:4096
    v_mfma_f32_16x16x32_bf16 v[188:191], v[88:91], v[220:223], v[188:191]
    ds_write_b128 v100, v[152:155] offset:0
    v_mfma_f32_16x16x32_bf16 v[112:115], v[72:75], v[208:211], v[112:115]
    ds_write_b128 v100, v[156:159] offset:1024
    v_mfma_f32_16x16x32_bf16 v[116:119], v[76:79], v[208:211], v[116:119]
    ds_write_b128 v100, v[160:163] offset:2048
    v_mfma_f32_16x16x32_bf16 v[120:123], v[80:83], v[208:211], v[120:123]
    ds_write_b128 v100, v[164:167] offset:3072
    v_mfma_f32_16x16x32_bf16 v[124:127], v[84:87], v[208:211], v[124:127]
    ds_write_b128 v100, v[168:171] offset:4096
    v_mfma_f32_16x16x32_bf16 v[128:131], v[88:91], v[208:211], v[128:131]
    ds_write_b128 v101, v[172:175] offset:0
L_BACK13:
    ds_write_b128 v101, v[176:179] offset:1024
    ds_write_b128 v101, v[180:183] offset:2048
    ds_write_b128 v101, v[184:187] offset:3072
    ds_write_b128 v101, v[188:191] offset:4096
    v_add_u32 v11, 1, v11
    ds_write_b32 v9, v11
    ds_read_b32 v26, v10
    s_cmp_lg_u64 s[42:43], 0
    s_cbranch_scc1 SPIN_31
BACK_32:
    s_waitcnt vmcnt(0)
    ds_write_b128 v3, v[12:15] offset:0
    ds_write_b128 v3, v[16:19] offset:1024
    s_mov_b32 exec_hi, 0
    ds_write_b128 v3, v[20:23] offset:2048
    s_mov_b64 exec, -1
    ds_read_b64_tr_b16 v[44:45], v4 offset:0
    ds_read_b64_tr_b16 v[46:47], v4 offset:512
    ds_read_b64_tr_b16 v[48:49], v4 offset:1024
    ds_read_b64_tr_b16 v[50:51], v4 offset:1536
    ds_read_b64_tr_b16 v[52:53], v4 offset:2048
    s_waitcnt lgkmcnt(8)
    v_cmp_gt_u32 vcc, v11, v26
    s_nop 0
    s_cbranch_vccnz SPIN_33
BACK_34:
    ds_read_b128 v[192:195], v102 offset:0
    ds_read_b128 v[212:215], v102 offset:5120
    ds_read_b128 v[232:235], v102 offset:10240
    ds_read_b128 v[196:199], v102 offset:1024
    ds_read_b128 v[216:219], v102 offset:6144
    ds_read_b128 v[236:239], v102 offset:11264
    ds_read_b128 v[200:203], v102 offset:2048
    ds_read_b128 v[220:223], v102 offset:7168
    ds_read_b128 v[240:243], v102 offset:12288
    ds_read_b128 v[204:207], v102 offset:3072
    ds_read_b128 v[224:227], v102 offset:8192
    ds_read_b128 v[244:247], v102 offset:13312
    ds_read_b128 v[208:211], v102 offset:4096
    ds_read_b128 v[228:231], v102 offset:9216
    ds_read_b128 v[248:251], v102 offset:14336
    s_mov_b32 s6, 0xffff0000
    s_waitcnt lgkmcnt(15)
    v_lshlrev_b32 v132, 16, v44
    v_and_b32 v133, s6, v44
    v_lshlrev_b32 v134, 16, v45
    v_and_b32 v135, s6, v45
    v_lshlrev_b32 v136, 16, v46
    v_and_b32 v137, s6, v46
    v_lshlrev_b32 v138, 16, v47
    v_and_b32 v139, s6, v47
    v_lshlrev_b32 v140, 16, v48
    v_and_b32 v141, s6, v48
    v_lshlrev_b32 v142, 16, v49
    v_and_b32 v143, s6, v49
    v_lshlrev_b32 v144, 16, v50
    v_and_b32 v145, s6, v50
    v_lshlrev_b32 v146, 16, v51
    v_and_b32 v147, s6, v51
    v_lshlrev_b32 v148, 16, v52
    v_and_b32 v149, s6, v52
    v_lshlrev_b32 v150, 16, v53
    v_and_b32 v151, s6, v53
    v_lshlrev_b32 v152, 16, v32
    v_and_b32 v153, s6, v32
    v_lshlrev_b32 v154, 16, v33
    v_and_b32 v155, s6, v33
    v_lshlrev_b32 v156, 16, v34
    v_and_b32 v157, s6, v34
    v_lshlrev_b32 v158, 16, v35
    v_and_b32 v159, s6, v35
    v_lshlrev_b32 v160, 16, v36
    v_and_b32 v161, s6, v36
    v_lshlrev_b32 v162, 16, v37
    v_and_b32 v163, s6, v37
    v_lshlrev_b32 v164, 16, v38
    v_and_b32 v165, s6, v38
    v_lshlrev_b32 v166, 16, v39
    v_and_b32 v167, s6, v39
    v_lshlrev_b32 v168, 16, v40
    v_and_b32 v169, s6, v40
    v_lshlrev_b32 v170, 16, v41
    v_and_b32 v171, s6, v41
    v_lshlrev_b32 v172, 16, v42
    v_and_b32 v173, s6, v42
    v_lshlrev_b32 v174, 16, v43
    v_and_b32 v175, s6, v43
    s_waitcnt lgkmcnt(12)
    v_pk_add_f32 v[112:113], v[112:113], v[192:193]
    v_pk_add_f32 v[56:57], v[212:213], v[232:233]
    v_pk_add_f32 v[114:115], v[114:115], v[194:195]
    v_pk_add_f32 v[58:59], v[214:215], v[234:235]
    v_pk_add_f32 v[112:113], v[112:113], v[56:57]
    v_pk_add_f32 v[114:115], v[114:115], v[58:59]
    s_waitcnt lgkmcnt(9)
    v_pk_add_f32 v[116:117], v[116:117], v[196:197]
    v_pk_add_f32 v[56:57], v[216:217], v[236:237]
    v_pk_add_f32 v[118:119], v[118:119], v[198:199]
    v_pk_add_f32 v[58:59], v[218:219], v[238:239]
    v_pk_add_f32 v[116:117], v[116:117], v[56:57]
    v_pk_add_f32 v[118:119], v[118:119], v[58:59]
    s_waitcnt lgkmcnt(6)
    v_pk_add_f32 v[120:121], v[120:121], v[200:201]
    v_pk_add_f32 v[56:57], v[220:221], v[240:241]
    v_pk_add_f32 v[122:123], v[122:123], v[202:203]
    v_pk_add_f32 v[58:59], v[222:223], v[242:243]
    v_pk_add_f32 v[120:121], v[120:121], v[56:57]
    v_pk_add_f32 v[122:123], v[122:123], v[58:59]
    s_waitcnt lgkmcnt(3)
    v_pk_add_f32 v[124:125], v[124:125], v[204:205]
    v_pk_add_f32 v[56:57], v[224:225], v[244:245]
    v_pk_add_f32 v[126:127], v[126:127], v[206:207]
    v_pk_add_f32 v[58:59], v[226:227], v[246:247]
    v_pk_add_f32 v[124:125], v[124:125], v[56:57]
    v_pk_add_f32 v[126:127], v[126:127], v[58:59]
    s_waitcnt lgkmcnt(0)
    v_pk_add_f32 v[128:129], v[128:129], v[208:209]
    v_pk_add_f32 v[56:57], v[228:229], v[248:249]
    v_pk_add_f32 v[130:131], v[130:131], v[210:211]
    v_pk_add_f32 v[58:59], v[230:231], v[250:251]
    v_pk_add_f32 v[128:129], v[128:129], v[56:57]
    v_pk_add_f32 v[130:131], v[130:131], v[58:59]
    s_mov_b32 s0, 0xbfb8aa3b
    v_pk_mul_f32 v[60:61], v[112:113], s[0:1] op_sel_hi:[1,0]
    v_pk_mul_f32 v[62:63], v[114:115], s[0:1] op_sel_hi:[1,0]
    v_pk_mul_f32 v[64:65], v[116:117], s[0:1] op_sel_hi:[1,0]
    v_pk_mul_f32 v[66:67], v[118:119], s[0:1] op_sel_hi:[1,0]
    v_pk_mul_f32 v[68:69], v[120:121], s[0:1] op_sel_hi:[1,0]
    v_pk_mul_f32 v[70:71], v[122:123], s[0:1] op_sel_hi:[1,0]
    v_pk_mul_f32 v[72:73], v[124:125], s[0:1] op_sel_hi:[1,0]
    v_pk_mul_f32 v[74:75], v[126:127], s[0:1] op_sel_hi:[1,0]
    v_pk_mul_f32 v[76:77], v[128:129], s[0:1] op_sel_hi:[1,0]
    v_pk_mul_f32 v[78:79], v[130:131], s[0:1] op_sel_hi:[1,0]
    v_exp_f32 v60, v60
    v_exp_f32 v61, v61
    v_exp_f32 v62, v62
    v_exp_f32 v63, v63
    v_exp_f32 v64, v64
    v_exp_f32 v65, v65
    v_exp_f32 v66, v66
    v_exp_f32 v67, v67
    v_exp_f32 v68, v68
    v_exp_f32 v69, v69
    v_exp_f32 v70, v70
    v_exp_f32 v71, v71
    v_exp_f32 v72, v72
    v_exp_f32 v73, v73
    v_exp_f32 v74, v74
    v_exp_f32 v75, v75
    v_exp_f32 v76, v76
    v_exp_f32 v77, v77
    v_exp_f32 v78, v78
    v_exp_f32 v79, v79
    v_pk_mul_f32 v[112:113], v[112:113], v[132:133]
    v_pk_mul_f32 v[114:115], v[114:115], v[134:135]
    v_pk_mul_f32 v[116:117], v[116:117], v[136:137]
    v_pk_mul_f32 v[118:119], v[118:119], v[138:139]
    v_pk_mul_f32 v[120:121], v[120:121], v[140:141]
    v_pk_mul_f32 v[122:123], v[122:123], v[142:143]
    v_pk_mul_f32 v[124:125], v[124:125], v[144:145]
    v_pk_mul_f32 v[126:127], v[126:127], v[146:147]
    v_pk_mul_f32 v[128:129], v[128:129], v[148:149]
    v_pk_mul_f32 v[130:131], v[130:131], v[150:151]
    v_pk_add_f32 v[60:61], v[60:61], 1.0 op_sel_hi:[1,0]
    v_pk_add_f32 v[62:63], v[62:63], 1.0 op_sel_hi:[1,0]
    v_pk_add_f32 v[64:65], v[64:65], 1.0 op_sel_hi:[1,0]
    v_pk_add_f32 v[66:67], v[66:67], 1.0 op_sel_hi:[1,0]
    v_pk_add_f32 v[68:69], v[68:69], 1.0 op_sel_hi:[1,0]
    v_pk_add_f32 v[70:71], v[70:71], 1.0 op_sel_hi:[1,0]
    v_pk_add_f32 v[72:73], v[72:73], 1.0 op_sel_hi:[1,0]
    v_pk_add_f32 v[74:75], v[74:75], 1.0 op_sel_hi:[1,0]
    v_pk_add_f32 v[76:77], v[76:77], 1.0 op_sel_hi:[1,0]
    v_pk_add_f32 v[78:79], v[78:79], 1.0 op_sel_hi:[1,0]
    v_rcp_f32 v60, v60
    v_rcp_f32 v61, v61
    v_rcp_f32 v62, v62
    v_rcp_f32 v63, v63
    v_rcp_f32 v64, v64
    v_rcp_f32 v65, v65
    v_rcp_f32 v66, v66
    v_rcp_f32 v67, v67
    v_rcp_f32 v68, v68
    v_rcp_f32 v69, v69
    v_rcp_f32 v70, v70
    v_rcp_f32 v71, v71
    v_rcp_f32 v72, v72
    v_rcp_f32 v73, v73
    v_rcp_f32 v74, v74
    v_rcp_f32 v75, v75
    v_rcp_f32 v76, v76
    v_rcp_f32 v77, v77
    v_rcp_f32 v78, v78
    v_rcp_f32 v79, v79
    v_pk_mul_f32 v[112:113], v[112:113], v[60:61]
    v_pk_mul_f32 v[114:115], v[114:115], v[62:63]
    v_cvt_pk_bf16_f32 v44, v112, v113
    v_cvt_pk_bf16_f32 v45, v114, v115
    ds_write_b64 v103, v[44:45] offset:0
    v_pk_mul_f32 v[116:117], v[116:117], v[64:65]
    v_pk_mul_f32 v[118:119], v[118:119], v[66:67]
    v_cvt_pk_bf16_f32 v46, v116, v117
    v_cvt_pk_bf16_f32 v47, v118, v119
    ds_write_b64 v103, v[46:47] offset:32
    v_pk_mul_f32 v[120:121], v[120:121], v[68:69]
    v_pk_mul_f32 v[122:123], v[122:123], v[70:71]
    v_cvt_pk_bf16_f32 v48, v120, v121
    v_cvt_pk_bf16_f32 v49, v122, v123
    ds_write_b64 v103, v[48:49] offset:64
    v_pk_mul_f32 v[124:125], v[124:125], v[72:73]
    v_pk_mul_f32 v[126:127], v[126:127], v[74:75]
    v_cvt_pk_bf16_f32 v50, v124, v125
    v_cvt_pk_bf16_f32 v51, v126, v127
    ds_write_b64 v103, v[50:51] offset:96
    v_pk_mul_f32 v[128:129], v[128:129], v[76:77]
    v_pk_mul_f32 v[130:131], v[130:131], v[78:79]
    v_cvt_pk_bf16_f32 v52, v128, v129
    v_cvt_pk_bf16_f32 v53, v130, v131
    ds_write_b64 v103, v[52:53] offset:128
    ds_read_b128 v[192:195], v95
    ds_read_b128 v[196:199], v96
    ds_read_b128 v[200:203], v97
    s_waitcnt lgkmcnt(2)
    v_lshlrev_b32 v56, 16, v192
    v_and_b32 v57, s6, v192
    v_lshlrev_b32 v58, 16, v193
    v_and_b32 v59, s6, v193
    v_lshlrev_b32 v60, 16, v194
    v_and_b32 v61, s6, v194
    v_lshlrev_b32 v62, 16, v195
    v_and_b32 v63, s6, v195
    v_pk_add_f32 v[56:57], v[56:57], v[152:153]
    v_pk_add_f32 v[58:59], v[58:59], v[154:155]
    v_pk_add_f32 v[60:61], v[60:61], v[156:157]
    v_pk_add_f32 v[62:63], v[62:63], v[158:159]
    v_cvt_pk_bf16_f32 v208, v56, v57
    v_cvt_pk_bf16_f32 v209, v58, v59
    v_cvt_pk_bf16_f32 v210, v60, v61
    v_cvt_pk_bf16_f32 v211, v62, v63
    buffer_store_dwordx4 v[208:211], v92, s[68:71], s8 offen
    s_waitcnt lgkmcnt(1)
    v_lshlrev_b32 v56, 16, v196
    v_and_b32 v57, s6, v196
    v_lshlrev_b32 v58, 16, v197
    v_and_b32 v59, s6, v197
    v_lshlrev_b32 v60, 16, v198
    v_and_b32 v61, s6, v198
    v_lshlrev_b32 v62, 16, v199
    v_and_b32 v63, s6, v199
    v_pk_add_f32 v[56:57], v[56:57], v[160:161]
    v_pk_add_f32 v[58:59], v[58:59], v[162:163]
    v_pk_add_f32 v[60:61], v[60:61], v[164:165]
    v_pk_add_f32 v[62:63], v[62:63], v[166:167]
    v_cvt_pk_bf16_f32 v212, v56, v57
    v_cvt_pk_bf16_f32 v213, v58, v59
    v_cvt_pk_bf16_f32 v214, v60, v61
    v_cvt_pk_bf16_f32 v215, v62, v63
    buffer_store_dwordx4 v[212:215], v93, s[68:71], s8 offen
    s_waitcnt lgkmcnt(0)
    v_lshlrev_b32 v56, 16, v200
    v_and_b32 v57, s6, v200
    v_lshlrev_b32 v58, 16, v201
    v_and_b32 v59, s6, v201
    v_lshlrev_b32 v60, 16, v202
    v_and_b32 v61, s6, v202
    v_lshlrev_b32 v62, 16, v203
    v_and_b32 v63, s6, v203
    v_pk_add_f32 v[56:57], v[56:57], v[168:169]
    v_pk_add_f32 v[58:59], v[58:59], v[170:171]
    v_pk_add_f32 v[60:61], v[60:61], v[172:173]
    v_pk_add_f32 v[62:63], v[62:63], v[174:175]
    v_cvt_pk_bf16_f32 v216, v56, v57
    v_cvt_pk_bf16_f32 v217, v58, v59
    v_cvt_pk_bf16_f32 v218, v60, v61
    v_cvt_pk_bf16_f32 v219, v62, v63
    s_mov_b32 exec_hi, 0
    buffer_store_dwordx4 v[216:219], v94, s[68:71], s8 offen
    s_endpgm
L_IDLE:
    v_lshrrev_b32 v1, 3, v0
    s_mul_i32 s6, s3, 160
    v_add_u32 v2, s6, v1
    v_mul_u32_u24 v2, 3456, v2
    v_and_b32 v3, 7, v0
    v_lshl_add_u32 v2, v3, 4, v2
    v_lshlrev_b32 v4, 8, v1
    v_lshl_add_u32 v4, v3, 5, v4
    s_lshl_b32 s6, s3, 11
    v_add_u32 v4, s6, v4
    s_waitcnt lgkmcnt(0)
    s_lshl3_add_u32 s47, s5, s4
    s_lshl_b32 s9, s47, 7
    s_cmp_ge_u32 s47, 27
    s_cselect_b32 s9, 536870912, s9
    s_mov_b32 s64, s18
    s_mov_b32 s65, s19
    s_mov_b32 s66, 163840
    s_mov_b32 s67, 0x20000
    buffer_load_dword v112, v117, s[64:67], s60 offen nt
    s_mov_b32 s68, s20
    s_mov_b32 s69, s21
    s_mov_b32 s70, 163840
    s_mov_b32 s71, 0x20000
    buffer_load_dword v113, v117, s[68:71], s60 offen nt
    s_mov_b32 s72, s22
    s_mov_b32 s73, s23
    s_mov_b32 s74, 163840
    s_mov_b32 s75, 0x20000
    buffer_load_dword v114, v117, s[72:75], s60 offen nt
    s_mov_b32 s48, s24
    s_mov_b32 s49, s25
    s_mov_b32 s50, 163840
    s_mov_b32 s51, 0x20000
    buffer_load_dword v115, v117, s[48:51], s60 offen nt
    s_mov_b32 s64, s26
    s_mov_b32 s65, s27
    s_mov_b32 s66, 1280
    s_mov_b32 s67, 0x20000
    buffer_load_ushort v116, v118, s[64:67], s61 offen
    s_barrier
    s_mov_b32 s56, s32
    s_mov_b32 s57, s33
    s_mov_b32 s58, 2211840
    s_mov_b32 s59, 0x20000
    s_mov_b32 s0, s9
    buffer_load_dwordx4 v[12:15], v2, s[56:59], s0 offen
    s_add_u32 s0, s0, 27648
    buffer_load_dwordx4 v[16:19], v2, s[56:59], s0 offen
    s_add_u32 s0, s0, 27648
    buffer_load_dwordx4 v[20:23], v2, s[56:59], s0 offen
    s_add_u32 s0, s0, 27648
    buffer_load_dwordx4 v[24:27], v2, s[56:59], s0 offen
    s_add_u32 s0, s0, 27648
    buffer_load_dwordx4 v[28:31], v2, s[56:59], s0 offen
    s_add_u32 s0, s0, 27648
    buffer_load_dwordx4 v[32:35], v2, s[56:59], s0 offen
    s_add_u32 s0, s0, 27648
    buffer_load_dwordx4 v[36:39], v2, s[56:59], s0 offen
    s_add_u32 s0, s0, 27648
    buffer_load_dwordx4 v[40:43], v2, s[56:59], s0 offen
    s_add_u32 s0, s0, 27648
    buffer_load_dwordx4 v[44:47], v2, s[56:59], s0 offen
    s_add_u32 s0, s0, 27648
    buffer_load_dwordx4 v[48:51], v2, s[56:59], s0 offen
    s_add_u32 s0, s0, 27648
    buffer_load_dwordx4 v[52:55], v2, s[56:59], s0 offen
    s_add_u32 s0, s0, 27648
    buffer_load_dwordx4 v[56:59], v2, s[56:59], s0 offen
    s_add_u32 s0, s0, 27648
    buffer_load_dwordx4 v[60:63], v2, s[56:59], s0 offen
    s_add_u32 s0, s0, 27648
    buffer_load_dwordx4 v[64:67], v2, s[56:59], s0 offen
    s_add_u32 s0, s0, 27648
    buffer_load_dwordx4 v[68:71], v2, s[56:59], s0 offen
    s_add_u32 s0, s0, 27648
    buffer_load_dwordx4 v[72:75], v2, s[56:59], s0 offen
    s_add_u32 s0, s0, 27648
    buffer_load_dwordx4 v[76:79], v2, s[56:59], s0 offen
    s_add_u32 s0, s0, 27648
    buffer_load_dwordx4 v[80:83], v2, s[56:59], s0 offen
    s_add_u32 s0, s0, 27648
    buffer_load_dwordx4 v[84:87], v2, s[56:59], s0 offen
    s_add_u32 s0, s0, 27648
    buffer_load_dwordx4 v[88:91], v2, s[56:59], s0 offen
    s_mov_b32 s56, s34
    s_mov_b32 s57, s35
    s_mov_b32 s58, 3456
    s_mov_b32 s59, 0x20000
    v_lshlrev_b32 v5, 1, v0
    buffer_load_ushort v7, v5, s[56:59], s9 offen
    s_mov_b32 s52, s16
    s_mov_b32 s53, s17
    s_mov_b32 s54, 2621440
    s_mov_b32 s55, 0x20000
    s_mov_b32 s48, s44
    s_mov_b32 s49, s45
    s_mov_b32 s50, 16777216
    s_mov_b32 s51, 0x20000
    s_mov_b32 s64, s38
    s_mov_b32 s65, s39
    s_mov_b32 s66, 1280
    s_mov_b32 s67, 0x20000
    s_mov_b32 s68, s40
    s_mov_b32 s69, s41
    s_mov_b32 s70, 2621440
    s_mov_b32 s71, 0x20000
    s_mov_b32 s72, s42
    s_mov_b32 s73, s43
    s_mov_b32 s74, 256
    s_mov_b32 s75, 0x20000
    s_cmp_lt_u32 s3, 2
    s_cselect_b32 s0, 14, 13
    s_cselect_b64 s[24:25], -1, 0
    s_mov_b32 s6, s15
    s_lshl2_add_u32 s7, s6, s3
    s_lshl_b32 s76, s7, 10
    s_add_u32 s6, s6, 1
    s_cmp_eq_u32 s6, s0
    s_cselect_b32 s6, 0, s6
    s_lshl2_add_u32 s7, s6, s3
    s_lshl_b32 s77, s7, 10
    s_add_u32 s6, s6, 1
    s_cmp_eq_u32 s6, s0
    s_cselect_b32 s6, 0, s6
    s_lshl2_add_u32 s7, s6, s3
    s_lshl_b32 s78, s7, 10
    s_add_u32 s6, s6, 1
    s_cmp_eq_u32 s6, s0
    s_cselect_b32 s6, 0, s6
    s_lshl2_add_u32 s7, s6, s3
    s_lshl_b32 s79, s7, 10
    s_add_u32 s6, s6, 1
    s_cmp_eq_u32 s6, s0
    s_cselect_b32 s6, 0, s6
    s_lshl2_add_u32 s7, s6, s3
    s_lshl_b32 s80, s7, 10
    s_add_u32 s6, s6, 1
    s_cmp_eq_u32 s6, s0
    s_cselect_b32 s6, 0, s6
    s_lshl2_add_u32 s7, s6, s3
    s_lshl_b32 s81, s7, 10
    s_add_u32 s6, s6, 1
    s_cmp_eq_u32 s6, s0
    s_cselect_b32 s6, 0, s6
    s_lshl2_add_u32 s7, s6, s3
    s_lshl_b32 s82, s7, 10
    s_add_u32 s6, s6, 1
    s_cmp_eq_u32 s6, s0
    s_cselect_b32 s6, 0, s6
    s_lshl2_add_u32 s7, s6, s3
    s_lshl_b32 s83, s7, 10
    s_add_u32 s6, s6, 1
    s_cmp_eq_u32 s6, s0
    s_cselect_b32 s6, 0, s6
    s_lshl2_add_u32 s7, s6, s3
    s_lshl_b32 s84, s7, 10
    s_add_u32 s6, s6, 1
    s_cmp_eq_u32 s6, s0
    s_cselect_b32 s6, 0, s6
    s_lshl2_add_u32 s7, s6, s3
    s_lshl_b32 s85, s7, 10
    s_add_u32 s6, s6, 1
    s_cmp_eq_u32 s6, s0
    s_cselect_b32 s6, 0, s6
    s_lshl2_add_u32 s7, s6, s3
    s_lshl_b32 s86, s7, 10
    s_add_u32 s6, s6, 1
    s_cmp_eq_u32 s6, s0
    s_cselect_b32 s6, 0, s6
    s_lshl2_add_u32 s7, s6, s3
    s_lshl_b32 s87, s7, 10
    s_add_u32 s6, s6, 1
    s_cmp_eq_u32 s6, s0
    s_cselect_b32 s6, 0, s6
    s_lshl2_add_u32 s7, s6, s3
    s_lshl_b32 s88, s7, 10
    s_add_u32 s6, s6, 1
    s_cmp_eq_u32 s6, s0
    s_cselect_b32 s6, 0, s6
    s_lshl2_add_u32 s7, s6, s3
    s_lshl_b32 s89, s7, 10
    s_cmp_ge_u32 s62, 640
    s_cbranch_scc1 NOH_35
    s_mul_i32 s6, s3, 8448
    s_add_u32 s6, s6, 32768
    v_lshlrev_b32 v164, 3, v0
    v_add_u32 v164, s6, v164
    v_mul_u32_u24 v165, 528, v8
    v_lshl_add_u32 v165, v10, 4, v165
    v_add_u32 v165, s6, v165
    s_mul_i32 s6, s3, 18176
    s_add_u32 s6, s6, 98304
    v_lshlrev_b32 v167, 1, v8
    v_lshl_add_u32 v167, v10, 7, v167
    v_add_u32 v167, s6, v167
    v_lshlrev_b32 v168, 2, v8
    v_lshrrev_b32 v169, 1, v10
    v_lshl_add_u32 v168, v169, 1, v168
    v_add_u32 v168, s6, v168
    v_mov_b32 v160, 1.0
    v_mov_b32 v161, 1.0
    v_mov_b32 v162, 0
    v_mov_b32 v163, 0
    s_waitcnt vmcnt(21)
    v_lshlrev_b32 v116, 16, v116
    v_mul_f32 v116, 1069066811, v116
    v_exp_f32 v116, v116
    v_lshlrev_b32 v120, 16, v112
    v_and_b32 v121, 0xffff0000, v112
    v_lshlrev_b32 v122, 16, v113
    v_and_b32 v123, 0xffff0000, v113
    v_lshlrev_b32 v124, 16, v114
    v_and_b32 v125, 0xffff0000, v114
    v_lshlrev_b32 v126, 16, v115
    v_and_b32 v127, 0xffff0000, v115
    v_cvt_pk_bf16_f32 v116, v116, v116
    v_and_b32 v116, 0xffff0000, v116
    v_mul_f32 v120, 1069066811, v120
    v_mul_f32 v121, 1069066811, v121
    v_exp_f32 v120, v120
    v_exp_f32 v121, v121
    v_add_f32 v112, v116, v116
    v_cvt_pk_bf16_f32 v113, v120, v121
    v_lshlrev_b32 v120, 16, v113
    v_and_b32 v121, 0xffff0000, v113
    v_pk_mul_f32 v[120:121], v[120:121], v[116:117] op_sel_hi:[1,0]
    v_pk_mul_f32 v[122:123], v[122:123], v[116:117] op_sel_hi:[1,0]
    v_pk_mul_f32 v[124:125], v[124:125], v[112:113] op_sel_hi:[1,0]
    v_pk_mul_f32 v[126:127], v[126:127], v[112:113] op_sel_hi:[1,0]
    v_mul_f32 v120, 0xbfb8aa3b, v120
    v_mul_f32 v122, 1042479491, v122
    v_mul_f32 v121, 0xbfb8aa3b, v121
    v_mul_f32 v123, 1042479491, v123
    v_mul_f32 v144, 0x41000000, v120
    v_mul_f32 v145, 0x41000000, v121
    v_mul_f32 v146, 0x41000000, v122
    v_mul_f32 v147, 0x41000000, v123
    v_mul_f32 v148, 0x43000000, v120
    v_mul_f32 v149, 0x43000000, v121
    v_mul_f32 v150, 0x43000000, v122
    v_mul_f32 v151, 0x43000000, v123
    v_mul_f32 v152, 0x44000000, v120
    v_mul_f32 v153, 0x44000000, v121
    v_mul_f32 v154, 0x44000000, v122
    v_mul_f32 v155, 0x44000000, v123
    v_mul_f32 v156, 0x44010000, v120
    v_mul_f32 v157, 0x44010000, v121
    v_mul_f32 v158, 0x44010000, v122
    v_mul_f32 v159, 0x44010000, v123
    v_exp_f32 v144, v144
    v_fract_f32 v146, v146
    v_exp_f32 v145, v145
    v_fract_f32 v147, v147
    v_exp_f32 v148, v148
    v_fract_f32 v150, v150
    v_exp_f32 v149, v149
    v_fract_f32 v151, v151
    v_exp_f32 v152, v152
    v_fract_f32 v154, v154
    v_exp_f32 v153, v153
    v_fract_f32 v155, v155
    v_exp_f32 v156, v156
    v_fract_f32 v158, v158
    v_exp_f32 v157, v157
    v_fract_f32 v159, v159
    v_cos_f32 v128, v146
    v_sin_f32 v130, v146
    v_cos_f32 v129, v147
    v_sin_f32 v131, v147
    v_cos_f32 v132, v150
    v_sin_f32 v134, v150
    v_cos_f32 v133, v151
    v_sin_f32 v135, v151
    v_cos_f32 v136, v154
    v_sin_f32 v138, v154
    v_cos_f32 v137, v155
    v_sin_f32 v139, v155
    v_cos_f32 v140, v158
    v_sin_f32 v142, v158
    v_cos_f32 v141, v159
    v_sin_f32 v143, v159
    v_pk_mul_f32 v[128:129], v[128:129], v[144:145]
    v_pk_mul_f32 v[130:131], v[130:131], v[144:145] neg_lo:[1,0] neg_hi:[1,0]
    v_pk_mul_f32 v[132:133], v[132:133], v[148:149]
    v_pk_mul_f32 v[134:135], v[134:135], v[148:149]
    v_pk_mul_f32 v[136:137], v[136:137], v[152:153]
    v_pk_mul_f32 v[138:139], v[138:139], v[152:153]
    v_pk_mul_f32 v[140:141], v[140:141], v[156:157]
    v_pk_mul_f32 v[142:143], v[142:143], v[156:157]
    v_pk_mul_f32 v[144:145], v[138:139], v[126:127]
    v_pk_mul_f32 v[146:147], v[142:143], v[126:127]
    v_pk_mul_f32 v[138:139], v[138:139], v[124:125]
    v_pk_mul_f32 v[142:143], v[142:143], v[124:125]
    v_pk_fma_f32 v[138:139], v[136:137], v[126:127], v[138:139]
    v_pk_fma_f32 v[142:143], v[140:141], v[126:127], v[142:143]
    v_pk_fma_f32 v[136:137], v[136:137], v[124:125], v[144:145] neg_lo:[0,0,1] neg_hi:[0,0,1]
    v_pk_fma_f32 v[140:141], v[140:141], v[124:125], v[146:147] neg_lo:[0,0,1] neg_hi:[0,0,1]
    s_mov_b32 s63, 4
    v_mov_b32 v166, v164
HY_36:
    v_cvt_pk_bf16_f32 v144, v160, v162
    v_cvt_pk_bf16_f32 v145, v161, v163
    v_pk_mul_f32 v[152:153], v[162:163], v[130:131]
    ds_write_b64 v166, v[144:145] offset:0
    v_pk_mul_f32 v[162:163], v[162:163], v[128:129]
    v_pk_fma_f32 v[162:163], v[160:161], v[130:131], v[162:163]
    v_pk_fma_f32 v[160:161], v[160:161], v[128:129], v[152:153] neg_lo:[0,0,1] neg_hi:[0,0,1]
    v_cvt_pk_bf16_f32 v148, v160, v162
    v_cvt_pk_bf16_f32 v149, v161, v163
    v_pk_mul_f32 v[152:153], v[162:163], v[130:131]
    ds_write_b64 v166, v[148:149] offset:528
    v_pk_mul_f32 v[162:163], v[162:163], v[128:129]
    v_pk_fma_f32 v[162:163], v[160:161], v[130:131], v[162:163]
    v_pk_fma_f32 v[160:161], v[160:161], v[128:129], v[152:153] neg_lo:[0,0,1] neg_hi:[0,0,1]
    v_cvt_pk_bf16_f32 v144, v160, v162
    v_cvt_pk_bf16_f32 v145, v161, v163
    v_pk_mul_f32 v[152:153], v[162:163], v[130:131]
    ds_write_b64 v166, v[144:145] offset:1056
    v_pk_mul_f32 v[162:163], v[162:163], v[128:129]
    v_pk_fma_f32 v[162:163], v[160:161], v[130:131], v[162:163]
    v_pk_fma_f32 v[160:161], v[160:161], v[128:129], v[152:153] neg_lo:[0,0,1] neg_hi:[0,0,1]
    v_cvt_pk_bf16_f32 v148, v160, v162
    v_cvt_pk_bf16_f32 v149, v161, v163
    v_pk_mul_f32 v[152:153], v[162:163], v[130:131]
    ds_write_b64 v166, v[148:149] offset:1584
    v_pk_mul_f32 v[162:163], v[162:163], v[128:129]
    v_pk_fma_f32 v[162:163], v[160:161], v[130:131], v[162:163]
    v_pk_fma_f32 v[160:161], v[160:161], v[128:129], v[152:153] neg_lo:[0,0,1] neg_hi:[0,0,1]
    v_add_u32 v166, 2112, v166
    s_sub_u32 s63, s63, 1
    s_cmp_lg_u32 s63, 0
    s_cbranch_scc1 HY_36
    ds_read_b128 v[176:179], v165 offset:0
    ds_read_b128 v[180:183], v165 offset:64
    ds_read_b128 v[184:187], v165 offset:128
    ds_read_b128 v[188:191], v165 offset:192
    ds_read_b128 v[192:195], v165 offset:256
    ds_read_b128 v[196:199], v165 offset:320
    ds_read_b128 v[200:203], v165 offset:384
    ds_read_b128 v[204:207], v165 offset:448
    v_cvt_pk_bf16_f32 v144, v136, v138
    v_cvt_pk_bf16_f32 v145, v137, v139
    v_cvt_pk_bf16_f32 v146, v140, v142
    v_cvt_pk_bf16_f32 v147, v141, v143
    v_pk_mul_f32 v[152:153], v[138:139], v[134:135]
    v_pk_mul_f32 v[154:155], v[142:143], v[134:135]
    ds_write_b64 v164, v[144:145] offset:0
    ds_write_b64 v164, v[146:147] offset:6336
    v_pk_mul_f32 v[138:139], v[138:139], v[132:133]
    v_pk_mul_f32 v[142:143], v[142:143], v[132:133]
    v_pk_fma_f32 v[138:139], v[136:137], v[134:135], v[138:139]
    v_pk_fma_f32 v[142:143], v[140:141], v[134:135], v[142:143]
    v_pk_fma_f32 v[136:137], v[136:137], v[132:133], v[152:153] neg_lo:[0,0,1] neg_hi:[0,0,1]
    v_pk_fma_f32 v[140:141], v[140:141], v[132:133], v[154:155] neg_lo:[0,0,1] neg_hi:[0,0,1]
    v_cvt_pk_bf16_f32 v148, v136, v138
    v_cvt_pk_bf16_f32 v149, v137, v139
    v_cvt_pk_bf16_f32 v150, v140, v142
    v_cvt_pk_bf16_f32 v151, v141, v143
    v_pk_mul_f32 v[152:153], v[138:139], v[134:135]
    v_pk_mul_f32 v[154:155], v[142:143], v[134:135]
    ds_write_b64 v164, v[148:149] offset:528
    ds_write_b64 v164, v[150:151] offset:6864
    v_pk_mul_f32 v[138:139], v[138:139], v[132:133]
    v_pk_mul_f32 v[142:143], v[142:143], v[132:133]
    v_pk_fma_f32 v[138:139], v[136:137], v[134:135], v[138:139]
    v_pk_fma_f32 v[142:143], v[140:141], v[134:135], v[142:143]
    v_pk_fma_f32 v[136:137], v[136:137], v[132:133], v[152:153] neg_lo:[0,0,1] neg_hi:[0,0,1]
    v_pk_fma_f32 v[140:141], v[140:141], v[132:133], v[154:155] neg_lo:[0,0,1] neg_hi:[0,0,1]
    v_cvt_pk_bf16_f32 v144, v136, v138
    v_cvt_pk_bf16_f32 v145, v137, v139
    v_cvt_pk_bf16_f32 v146, v140, v142
    v_cvt_pk_bf16_f32 v147, v141, v143
    v_pk_mul_f32 v[152:153], v[138:139], v[134:135]
    v_pk_mul_f32 v[154:155], v[142:143], v[134:135]
    ds_write_b64 v164, v[144:145] offset:1056
    ds_write_b64 v164, v[146:147] offset:7392
    v_pk_mul_f32 v[138:139], v[138:139], v[132:133]
    v_pk_mul_f32 v[142:143], v[142:143], v[132:133]
    v_pk_fma_f32 v[138:139], v[136:137], v[134:135], v[138:139]
    v_pk_fma_f32 v[142:143], v[140:141], v[134:135], v[142:143]
    v_pk_fma_f32 v[136:137], v[136:137], v[132:133], v[152:153] neg_lo:[0,0,1] neg_hi:[0,0,1]
    v_pk_fma_f32 v[140:141], v[140:141], v[132:133], v[154:155] neg_lo:[0,0,1] neg_hi:[0,0,1]
    v_cvt_pk_bf16_f32 v148, v136, v138
    v_cvt_pk_bf16_f32 v149, v137, v139
    v_cvt_pk_bf16_f32 v150, v140, v142
    v_cvt_pk_bf16_f32 v151, v141, v143
    v_pk_mul_f32 v[152:153], v[138:139], v[134:135]
    v_pk_mul_f32 v[154:155], v[142:143], v[134:135]
    ds_write_b64 v164, v[148:149] offset:1584
    ds_write_b64 v164, v[150:151] offset:7920
    v_pk_mul_f32 v[138:139], v[138:139], v[132:133]
    v_pk_mul_f32 v[142:143], v[142:143], v[132:133]
    v_pk_fma_f32 v[138:139], v[136:137], v[134:135], v[138:139]
    v_pk_fma_f32 v[142:143], v[140:141], v[134:135], v[142:143]
    v_pk_fma_f32 v[136:137], v[136:137], v[132:133], v[152:153] neg_lo:[0,0,1] neg_hi:[0,0,1]
    v_pk_fma_f32 v[140:141], v[140:141], v[132:133], v[154:155] neg_lo:[0,0,1] neg_hi:[0,0,1]
    v_cvt_pk_bf16_f32 v144, v136, v138
    v_cvt_pk_bf16_f32 v145, v137, v139
    v_pk_mul_f32 v[152:153], v[138:139], v[134:135]
    ds_write_b64 v164, v[144:145] offset:2112
    v_pk_mul_f32 v[138:139], v[138:139], v[132:133]
    v_pk_fma_f32 v[138:139], v[136:137], v[134:135], v[138:139]
    v_pk_fma_f32 v[136:137], v[136:137], v[132:133], v[152:153] neg_lo:[0,0,1] neg_hi:[0,0,1]
    v_cvt_pk_bf16_f32 v148, v136, v138
    v_cvt_pk_bf16_f32 v149, v137, v139
    v_pk_mul_f32 v[152:153], v[138:139], v[134:135]
    ds_write_b64 v164, v[148:149] offset:2640
    v_pk_mul_f32 v[138:139], v[138:139], v[132:133]
    v_pk_fma_f32 v[138:139], v[136:137], v[134:135], v[138:139]
    v_pk_fma_f32 v[136:137], v[136:137], v[132:133], v[152:153] neg_lo:[0,0,1] neg_hi:[0,0,1]
    v_cvt_pk_bf16_f32 v144, v136, v138
    v_cvt_pk_bf16_f32 v145, v137, v139
    v_pk_mul_f32 v[152:153], v[138:139], v[134:135]
    ds_write_b64 v164, v[144:145] offset:3168
    v_pk_mul_f32 v[138:139], v[138:139], v[132:133]
    v_pk_fma_f32 v[138:139], v[136:137], v[134:135], v[138:139]
    v_pk_fma_f32 v[136:137], v[136:137], v[132:133], v[152:153] neg_lo:[0,0,1] neg_hi:[0,0,1]
    v_cvt_pk_bf16_f32 v148, v136, v138
    v_cvt_pk_bf16_f32 v149, v137, v139
    v_pk_mul_f32 v[152:153], v[138:139], v[134:135]
    ds_write_b64 v164, v[148:149] offset:3696
    v_pk_mul_f32 v[138:139], v[138:139], v[132:133]
    v_pk_fma_f32 v[138:139], v[136:137], v[134:135], v[138:139]
    v_pk_fma_f32 v[136:137], v[136:137], v[132:133], v[152:153] neg_lo:[0,0,1] neg_hi:[0,0,1]
    v_cvt_pk_bf16_f32 v144, v136, v138
    v_cvt_pk_bf16_f32 v145, v137, v139
    v_pk_mul_f32 v[152:153], v[138:139], v[134:135]
    ds_write_b64 v164, v[144:145] offset:4224
    v_pk_mul_f32 v[138:139], v[138:139], v[132:133]
    v_pk_fma_f32 v[138:139], v[136:137], v[134:135], v[138:139]
    v_pk_fma_f32 v[136:137], v[136:137], v[132:133], v[152:153] neg_lo:[0,0,1] neg_hi:[0,0,1]
    v_cvt_pk_bf16_f32 v148, v136, v138
    v_cvt_pk_bf16_f32 v149, v137, v139
    v_pk_mul_f32 v[152:153], v[138:139], v[134:135]
    ds_write_b64 v164, v[148:149] offset:4752
    v_pk_mul_f32 v[138:139], v[138:139], v[132:133]
    v_pk_fma_f32 v[138:139], v[136:137], v[134:135], v[138:139]
    v_pk_fma_f32 v[136:137], v[136:137], v[132:133], v[152:153] neg_lo:[0,0,1] neg_hi:[0,0,1]
    v_cvt_pk_bf16_f32 v144, v136, v138
    v_cvt_pk_bf16_f32 v145, v137, v139
    v_pk_mul_f32 v[152:153], v[138:139], v[134:135]
    ds_write_b64 v164, v[144:145] offset:5280
    v_pk_mul_f32 v[138:139], v[138:139], v[132:133]
    v_pk_fma_f32 v[138:139], v[136:137], v[134:135], v[138:139]
    v_pk_fma_f32 v[136:137], v[136:137], v[132:133], v[152:153] neg_lo:[0,0,1] neg_hi:[0,0,1]
    v_cvt_pk_bf16_f32 v148, v136, v138
    v_cvt_pk_bf16_f32 v149, v137, v139
    v_pk_mul_f32 v[152:153], v[138:139], v[134:135]
    ds_write_b64 v164, v[148:149] offset:5808
    v_pk_mul_f32 v[138:139], v[138:139], v[132:133]
    v_pk_fma_f32 v[138:139], v[136:137], v[134:135], v[138:139]
    v_pk_fma_f32 v[136:137], v[136:137], v[132:133], v[152:153] neg_lo:[0,0,1] neg_hi:[0,0,1]
    ds_read_b128 v[208:211], v165 offset:0
    ds_read_b128 v[212:215], v165 offset:64
    ds_read_b128 v[216:219], v165 offset:128
    ds_read_b128 v[220:223], v165 offset:192
    ds_read_b128 v[224:227], v165 offset:256
    ds_read_b128 v[228:231], v165 offset:320
    ds_read_b128 v[232:235], v165 offset:384
    ds_read_b128 v[236:239], v165 offset:448
    s_waitcnt lgkmcnt(7)
    v_mfma_f32_16x16x32_bf16 v[240:243], v[208:211], v[176:179], 0
    s_waitcnt lgkmcnt(6)
    v_mfma_f32_16x16x32_bf16 v[240:243], v[212:215], v[180:183], v[240:243]
    s_waitcnt lgkmcnt(5)
    v_mfma_f32_16x16x32_bf16 v[240:243], v[216:219], v[184:187], v[240:243]
    s_waitcnt lgkmcnt(4)
    v_mfma_f32_16x16x32_bf16 v[240:243], v[220:223], v[188:191], v[240:243]
    s_waitcnt lgkmcnt(3)
    v_mfma_f32_16x16x32_bf16 v[240:243], v[224:227], v[192:195], v[240:243]
    s_waitcnt lgkmcnt(2)
    v_mfma_f32_16x16x32_bf16 v[240:243], v[228:231], v[196:199], v[240:243]
    s_waitcnt lgkmcnt(1)
    v_mfma_f32_16x16x32_bf16 v[240:243], v[232:235], v[200:203], v[240:243]
    s_waitcnt lgkmcnt(0)
    v_mfma_f32_16x16x32_bf16 v[240:243], v[236:239], v[204:207], v[240:243]
    s_nop 7
    v_cvt_pk_bf16_f32 v144, v240, v240
    v_cvt_pk_bf16_f32 v145, v241, v241
    v_cvt_pk_bf16_f32 v146, v242, v242
    v_cvt_pk_bf16_f32 v147, v243, v243
    s_mov_b32 exec_lo, 0xffff
    s_mov_b32 exec_hi, 0xffff0000
    ds_write_b16 v168, v144 offset:768
    ds_write_b16 v168, v145 offset:832
    ds_write_b16 v168, v146 offset:896
    ds_write_b16 v168, v147 offset:960
    s_mov_b32 exec_lo, 0xffff0000
    s_mov_b32 exec_hi, 0xffff
    ds_write_b16 v167, v144 offset:896
    ds_write_b16 v167, v145 offset:928
    ds_write_b16 v167, v146 offset:960
    ds_write_b16 v167, v147 offset:992
    s_mov_b64 exec, -1
NOH_35:
    s_waitcnt vmcnt(0)
    s_mov_b32 s6, 0xffff0000
    v_lshlrev_b32 v100, 16, v12
    v_and_b32 v101, s6, v12
    v_lshlrev_b32 v102, 16, v13
    v_and_b32 v103, s6, v13
    v_lshlrev_b32 v104, 16, v14
    v_and_b32 v105, s6, v14
    v_lshlrev_b32 v106, 16, v15
    v_and_b32 v107, s6, v15
    v_lshlrev_b32 v92, 16, v16
    v_and_b32 v93, s6, v16
    v_lshlrev_b32 v94, 16, v17
    v_and_b32 v95, s6, v17
    v_lshlrev_b32 v96, 16, v18
    v_and_b32 v97, s6, v18
    v_lshlrev_b32 v98, 16, v19
    v_and_b32 v99, s6, v19
    v_pk_add_f32 v[100:101], v[100:101], v[92:93]
    v_pk_add_f32 v[102:103], v[102:103], v[94:95]
    v_pk_add_f32 v[104:105], v[104:105], v[96:97]
    v_pk_add_f32 v[106:107], v[106:107], v[98:99]
    v_lshlrev_b32 v92, 16, v20
    v_and_b32 v93, s6, v20
    v_lshlrev_b32 v94, 16, v21
    v_and_b32 v95, s6, v21
    v_lshlrev_b32 v96, 16, v22
    v_and_b32 v97, s6, v22
    v_lshlrev_b32 v98, 16, v23
    v_and_b32 v99, s6, v23
    v_pk_add_f32 v[100:101], v[100:101], v[92:93]
    v_pk_add_f32 v[102:103], v[102:103], v[94:95]
    v_pk_add_f32 v[104:105], v[104:105], v[96:97]
    v_pk_add_f32 v[106:107], v[106:107], v[98:99]
    v_lshlrev_b32 v92, 16, v24
    v_and_b32 v93, s6, v24
    v_lshlrev_b32 v94, 16, v25
    v_and_b32 v95, s6, v25
    v_lshlrev_b32 v96, 16, v26
    v_and_b32 v97, s6, v26
    v_lshlrev_b32 v98, 16, v27
    v_and_b32 v99, s6, v27
    v_pk_add_f32 v[100:101], v[100:101], v[92:93]
    v_pk_add_f32 v[102:103], v[102:103], v[94:95]
    v_pk_add_f32 v[104:105], v[104:105], v[96:97]
    v_pk_add_f32 v[106:107], v[106:107], v[98:99]
    v_lshlrev_b32 v92, 16, v28
    v_and_b32 v93, s6, v28
    v_lshlrev_b32 v94, 16, v29
    v_and_b32 v95, s6, v29
    v_lshlrev_b32 v96, 16, v30
    v_and_b32 v97, s6, v30
    v_lshlrev_b32 v98, 16, v31
    v_and_b32 v99, s6, v31
    v_pk_add_f32 v[100:101], v[100:101], v[92:93]
    v_pk_add_f32 v[102:103], v[102:103], v[94:95]
    v_pk_add_f32 v[104:105], v[104:105], v[96:97]
    v_pk_add_f32 v[106:107], v[106:107], v[98:99]
    v_lshlrev_b32 v92, 16, v32
    v_and_b32 v93, s6, v32
    v_lshlrev_b32 v94, 16, v33
    v_and_b32 v95, s6, v33
    v_lshlrev_b32 v96, 16, v34
    v_and_b32 v97, s6, v34
    v_lshlrev_b32 v98, 16, v35
    v_and_b32 v99, s6, v35
    v_pk_add_f32 v[100:101], v[100:101], v[92:93]
    v_pk_add_f32 v[102:103], v[102:103], v[94:95]
    v_pk_add_f32 v[104:105], v[104:105], v[96:97]
    v_pk_add_f32 v[106:107], v[106:107], v[98:99]
    v_lshlrev_b32 v92, 16, v36
    v_and_b32 v93, s6, v36
    v_lshlrev_b32 v94, 16, v37
    v_and_b32 v95, s6, v37
    v_lshlrev_b32 v96, 16, v38
    v_and_b32 v97, s6, v38
    v_lshlrev_b32 v98, 16, v39
    v_and_b32 v99, s6, v39
    v_pk_add_f32 v[100:101], v[100:101], v[92:93]
    v_pk_add_f32 v[102:103], v[102:103], v[94:95]
    v_pk_add_f32 v[104:105], v[104:105], v[96:97]
    v_pk_add_f32 v[106:107], v[106:107], v[98:99]
    v_lshlrev_b32 v92, 16, v40
    v_and_b32 v93, s6, v40
    v_lshlrev_b32 v94, 16, v41
    v_and_b32 v95, s6, v41
    v_lshlrev_b32 v96, 16, v42
    v_and_b32 v97, s6, v42
    v_lshlrev_b32 v98, 16, v43
    v_and_b32 v99, s6, v43
    v_pk_add_f32 v[100:101], v[100:101], v[92:93]
    v_pk_add_f32 v[102:103], v[102:103], v[94:95]
    v_pk_add_f32 v[104:105], v[104:105], v[96:97]
    v_pk_add_f32 v[106:107], v[106:107], v[98:99]
    v_lshlrev_b32 v92, 16, v44
    v_and_b32 v93, s6, v44
    v_lshlrev_b32 v94, 16, v45
    v_and_b32 v95, s6, v45
    v_lshlrev_b32 v96, 16, v46
    v_and_b32 v97, s6, v46
    v_lshlrev_b32 v98, 16, v47
    v_and_b32 v99, s6, v47
    v_pk_add_f32 v[100:101], v[100:101], v[92:93]
    v_pk_add_f32 v[102:103], v[102:103], v[94:95]
    v_pk_add_f32 v[104:105], v[104:105], v[96:97]
    v_pk_add_f32 v[106:107], v[106:107], v[98:99]
    v_lshlrev_b32 v92, 16, v48
    v_and_b32 v93, s6, v48
    v_lshlrev_b32 v94, 16, v49
    v_and_b32 v95, s6, v49
    v_lshlrev_b32 v96, 16, v50
    v_and_b32 v97, s6, v50
    v_lshlrev_b32 v98, 16, v51
    v_and_b32 v99, s6, v51
    v_pk_add_f32 v[100:101], v[100:101], v[92:93]
    v_pk_add_f32 v[102:103], v[102:103], v[94:95]
    v_pk_add_f32 v[104:105], v[104:105], v[96:97]
    v_pk_add_f32 v[106:107], v[106:107], v[98:99]
    v_lshlrev_b32 v92, 16, v52
    v_and_b32 v93, s6, v52
    v_lshlrev_b32 v94, 16, v53
    v_and_b32 v95, s6, v53
    v_lshlrev_b32 v96, 16, v54
    v_and_b32 v97, s6, v54
    v_lshlrev_b32 v98, 16, v55
    v_and_b32 v99, s6, v55
    v_pk_add_f32 v[100:101], v[100:101], v[92:93]
    v_pk_add_f32 v[102:103], v[102:103], v[94:95]
    v_pk_add_f32 v[104:105], v[104:105], v[96:97]
    v_pk_add_f32 v[106:107], v[106:107], v[98:99]
    v_lshlrev_b32 v92, 16, v56
    v_and_b32 v93, s6, v56
    v_lshlrev_b32 v94, 16, v57
    v_and_b32 v95, s6, v57
    v_lshlrev_b32 v96, 16, v58
    v_and_b32 v97, s6, v58
    v_lshlrev_b32 v98, 16, v59
    v_and_b32 v99, s6, v59
    v_pk_add_f32 v[100:101], v[100:101], v[92:93]
    v_pk_add_f32 v[102:103], v[102:103], v[94:95]
    v_pk_add_f32 v[104:105], v[104:105], v[96:97]
    v_pk_add_f32 v[106:107], v[106:107], v[98:99]
    v_lshlrev_b32 v92, 16, v60
    v_and_b32 v93, s6, v60
    v_lshlrev_b32 v94, 16, v61
    v_and_b32 v95, s6, v61
    v_lshlrev_b32 v96, 16, v62
    v_and_b32 v97, s6, v62
    v_lshlrev_b32 v98, 16, v63
    v_and_b32 v99, s6, v63
    v_pk_add_f32 v[100:101], v[100:101], v[92:93]
    v_pk_add_f32 v[102:103], v[102:103], v[94:95]
    v_pk_add_f32 v[104:105], v[104:105], v[96:97]
    v_pk_add_f32 v[106:107], v[106:107], v[98:99]
    v_lshlrev_b32 v92, 16, v64
    v_and_b32 v93, s6, v64
    v_lshlrev_b32 v94, 16, v65
    v_and_b32 v95, s6, v65
    v_lshlrev_b32 v96, 16, v66
    v_and_b32 v97, s6, v66
    v_lshlrev_b32 v98, 16, v67
    v_and_b32 v99, s6, v67
    v_pk_add_f32 v[100:101], v[100:101], v[92:93]
    v_pk_add_f32 v[102:103], v[102:103], v[94:95]
    v_pk_add_f32 v[104:105], v[104:105], v[96:97]
    v_pk_add_f32 v[106:107], v[106:107], v[98:99]
    v_lshlrev_b32 v92, 16, v68
    v_and_b32 v93, s6, v68
    v_lshlrev_b32 v94, 16, v69
    v_and_b32 v95, s6, v69
    v_lshlrev_b32 v96, 16, v70
    v_and_b32 v97, s6, v70
    v_lshlrev_b32 v98, 16, v71
    v_and_b32 v99, s6, v71
    v_pk_add_f32 v[100:101], v[100:101], v[92:93]
    v_pk_add_f32 v[102:103], v[102:103], v[94:95]
    v_pk_add_f32 v[104:105], v[104:105], v[96:97]
    v_pk_add_f32 v[106:107], v[106:107], v[98:99]
    v_lshlrev_b32 v92, 16, v72
    v_and_b32 v93, s6, v72
    v_lshlrev_b32 v94, 16, v73
    v_and_b32 v95, s6, v73
    v_lshlrev_b32 v96, 16, v74
    v_and_b32 v97, s6, v74
    v_lshlrev_b32 v98, 16, v75
    v_and_b32 v99, s6, v75
    v_pk_add_f32 v[100:101], v[100:101], v[92:93]
    v_pk_add_f32 v[102:103], v[102:103], v[94:95]
    v_pk_add_f32 v[104:105], v[104:105], v[96:97]
    v_pk_add_f32 v[106:107], v[106:107], v[98:99]
    v_lshlrev_b32 v92, 16, v76
    v_and_b32 v93, s6, v76
    v_lshlrev_b32 v94, 16, v77
    v_and_b32 v95, s6, v77
    v_lshlrev_b32 v96, 16, v78
    v_and_b32 v97, s6, v78
    v_lshlrev_b32 v98, 16, v79
    v_and_b32 v99, s6, v79
    v_pk_add_f32 v[100:101], v[100:101], v[92:93]
    v_pk_add_f32 v[102:103], v[102:103], v[94:95]
    v_pk_add_f32 v[104:105], v[104:105], v[96:97]
    v_pk_add_f32 v[106:107], v[106:107], v[98:99]
    v_lshlrev_b32 v92, 16, v80
    v_and_b32 v93, s6, v80
    v_lshlrev_b32 v94, 16, v81
    v_and_b32 v95, s6, v81
    v_lshlrev_b32 v96, 16, v82
    v_and_b32 v97, s6, v82
    v_lshlrev_b32 v98, 16, v83
    v_and_b32 v99, s6, v83
    v_pk_add_f32 v[100:101], v[100:101], v[92:93]
    v_pk_add_f32 v[102:103], v[102:103], v[94:95]
    v_pk_add_f32 v[104:105], v[104:105], v[96:97]
    v_pk_add_f32 v[106:107], v[106:107], v[98:99]
    v_lshlrev_b32 v92, 16, v84
    v_and_b32 v93, s6, v84
    v_lshlrev_b32 v94, 16, v85
    v_and_b32 v95, s6, v85
    v_lshlrev_b32 v96, 16, v86
    v_and_b32 v97, s6, v86
    v_lshlrev_b32 v98, 16, v87
    v_and_b32 v99, s6, v87
    v_pk_add_f32 v[100:101], v[100:101], v[92:93]
    v_pk_add_f32 v[102:103], v[102:103], v[94:95]
    v_pk_add_f32 v[104:105], v[104:105], v[96:97]
    v_pk_add_f32 v[106:107], v[106:107], v[98:99]
    v_lshlrev_b32 v92, 16, v88
    v_and_b32 v93, s6, v88
    v_lshlrev_b32 v94, 16, v89
    v_and_b32 v95, s6, v89
    v_lshlrev_b32 v96, 16, v90
    v_and_b32 v97, s6, v90
    v_lshlrev_b32 v98, 16, v91
    v_and_b32 v99, s6, v91
    v_pk_add_f32 v[100:101], v[100:101], v[92:93]
    v_pk_add_f32 v[102:103], v[102:103], v[94:95]
    v_pk_add_f32 v[104:105], v[104:105], v[96:97]
    v_pk_add_f32 v[106:107], v[106:107], v[98:99]
    ds_write_b128 v4, v[100:103]
    ds_write_b128 v4, v[104:107] offset:16
    v_lshlrev_b32 v10, 2, v0
    v_add_u32 v10, 163072, v10
    s_cmp_eq_u32 s3, 0
    s_cselect_b32 s6, 1, 12
    v_mov_b32 v11, s6
    ds_write_b32 v9, v11
    s_cbranch_scc0 L_ID2
    ds_read_b32 v8, v10
    s_waitcnt lgkmcnt(0)
    v_cmp_gt_u32 vcc, 1, v8
    s_nop 0
    s_cbranch_vccnz SPIN_37
BACK_38:
    v_lshlrev_b32 v5, 2, v0
    ds_read_b32 v12, v5 offset:0
    ds_read_b32 v13, v5 offset:256
    ds_read_b32 v14, v5 offset:512
    ds_read_b32 v15, v5 offset:768
    ds_read_b32 v16, v5 offset:1024
    ds_read_b32 v17, v5 offset:1280
    ds_read_b32 v18, v5 offset:1536
    ds_read_b32 v19, v5 offset:1792
    ds_read_b32 v20, v5 offset:2048
    ds_read_b32 v21, v5 offset:2304
    ds_read_b32 v22, v5 offset:2560
    ds_read_b32 v23, v5 offset:2816
    ds_read_b32 v24, v5 offset:3072
    ds_read_b32 v25, v5 offset:3328
    ds_read_b32 v26, v5 offset:3584
    ds_read_b32 v27, v5 offset:3840
    ds_read_b32 v28, v5 offset:4096
    ds_read_b32 v29, v5 offset:4352
    ds_read_b32 v30, v5 offset:4608
    ds_read_b32 v31, v5 offset:4864
    ds_read_b32 v32, v5 offset:5120
    ds_read_b32 v33, v5 offset:5376
    ds_read_b32 v34, v5 offset:5632
    ds_read_b32 v35, v5 offset:5888
    ds_read_b32 v36, v5 offset:6144
    ds_read_b32 v37, v5 offset:6400
    ds_read_b32 v38, v5 offset:6656
    ds_read_b32 v39, v5 offset:6912
    ds_read_b32 v40, v5 offset:7168
    ds_read_b32 v41, v5 offset:7424
    ds_read_b32 v42, v5 offset:7680
    ds_read_b32 v43, v5 offset:7936
    s_waitcnt lgkmcnt(0)
    v_add_f32 v12, v12, v28
    v_add_f32 v13, v13, v29
    v_add_f32 v14, v14, v30
    v_add_f32 v15, v15, v31
    v_add_f32 v16, v16, v32
    v_add_f32 v17, v17, v33
    v_add_f32 v18, v18, v34
    v_add_f32 v19, v19, v35
    v_add_f32 v20, v20, v36
    v_add_f32 v21, v21, v37
    v_add_f32 v22, v22, v38
    v_add_f32 v23, v23, v39
    v_add_f32 v24, v24, v40
    v_add_f32 v25, v25, v41
    v_add_f32 v26, v26, v42
    v_add_f32 v27, v27, v43
    v_add_f32 v12, v12, v20
    v_add_f32 v13, v13, v21
    v_add_f32 v14, v14, v22
    v_add_f32 v15, v15, v23
    v_add_f32 v16, v16, v24
    v_add_f32 v17, v17, v25
    v_add_f32 v18, v18, v26
    v_add_f32 v19, v19, v27
    v_add_f32 v12, v12, v16
    v_add_f32 v13, v13, v17
    v_add_f32 v14, v14, v18
    v_add_f32 v15, v15, v19
    v_add_f32 v12, v12, v14
    v_add_f32 v13, v13, v15
    v_add_f32 v12, v12, v13
    v_mov_b32 v11, 12
    ds_write_b32 v9, v11
    v_cvt_pk_bf16_f32 v17, v12, v12
    v_lshl_or_b32 v16, v7, 16, v7
    v_and_b32 v13, 0xffff0000, v17
    v_sub_f32 v13, v12, v13
    v_cvt_pk_bf16_f32 v18, v13, v13
    v_and_b32 v14, 0xffff0000, v18
    v_sub_f32 v14, v13, v14
    v_cvt_pk_bf16_f32 v19, v12, v14
    v_mov_b32 v20, 0
    v_lshlrev_b32 v5, 4, v0
    s_lshl_b32 s6, s47, 10
    s_add_u32 s6, s6, 2818048
    s_cmp_ge_u32 s47, 27
    s_cselect_b32 s6, 536870912, s6
    buffer_store_dwordx4 v[16:19], v5, s[48:51], s6 offen sc1
    v_mov_b32 v2, 99588
    ds_read_b32 v8, v2
    s_waitcnt lgkmcnt(0)
    v_cmp_gt_u32 vcc, 1, v8
    s_nop 0
    s_cbranch_vccnz SPIN_39
BACK_40:
    s_lshr_b32 s6, s47, 1
    s_mul_i32 s6, s6, 128
    s_add_u32 s6, s6, 11264
    s_cmp_ge_u32 s47, 27
    s_cselect_b32 s6, 536870912, s6
    s_cmp_eq_u32 s47, 26
    s_cselect_b32 s7, 2, 1
    v_mov_b32 v5, s7
    s_waitcnt vmcnt(0)
    s_mov_b64 exec, 1
    buffer_atomic_add v5, v20, s[48:51], s6 offen sc1
    s_mov_b64 exec, -1
L_ID2:
    v_lshlrev_b32 v1, 4, v0
    s_mul_i32 s10, s14, 276480
    s_add_u32 s10, s10, 3145728
    s_mul_i32 s11, s13, 221184
    s_add_u32 s11, s11, 6291456
    s_xor_b32 s6, s3, 0
    s_lshl_b32 s6, s6, 10
    v_add_u32 v3, s6, v1
    s_xor_b32 s6, s3, 1
    s_lshl_b32 s6, s6, 10
    v_add_u32 v4, s6, v1
    s_xor_b32 s6, s3, 2
    s_lshl_b32 s6, s6, 10
    v_add_u32 v5, s6, v1
    s_xor_b32 s6, s3, 3
    s_lshl_b32 s6, s6, 10
    v_add_u32 v6, s6, v1
    v_mov_b32 v254, 99588
    v_lshrrev_b32 v8, 4, v0
    v_lshlrev_b32 v8, 3, v8
    s_mul_i32 s8, s14, 160
    ds_read_b32 v12, v254
    s_waitcnt lgkmcnt(0)
    v_cmp_gt_u32 vcc, 2, v12
    s_nop 0
    s_cbranch_vccnz SPIN_41
BACK_42:
    s_waitcnt vmcnt(0)
    s_branch L_G2
L_AUX:
    s_getpc_b64 s[96:97]
L_PC:
    s_sub_u32 s96, s96, L_PC-recurrent_scan__ssm_conv_s4d__mixer_channel_mlp__prompt_kernel
    s_subb_u32 s97, s97, 0
    s_and_b32 s6, s5, 7
    s_lshl_b32 s6, s6, 6
    v_add_u32 v1, s6, v0
    v_lshlrev_b32 v1, 7, v1
    v_min_u32 v1, L_LAST-recurrent_scan__ssm_conv_s4d__mixer_channel_mlp__prompt_kernel, v1
    s_cmp_lg_u32 s3, 6
    s_cbranch_scc1 L_PC2
    global_load_dword v255, v1, s[96:97]
L_PC2:
    s_and_b32 s6, s3, 3
    s_lshl_b32 s6, s6, 6
    s_add_u32 s6, s6, 163328
    v_and_b32 v9, 15, v0
    v_lshlrev_b32 v9, 2, v9
    v_add_u32 v9, s6, v9
    v_mov_b32 v11, 0
    ds_write_b32 v9, v11
    s_sub_u32 s13, s3, 4
    s_lshl_b32 s14, s4, 5
    s_add_u32 s14, s14, s5
    s_mul_i32 s15, s14, 10240
    v_lshrrev_b32 v1, 5, v0
    s_lshl_b32 s6, s13, 1
    v_add_u32 v1, s6, v1
    v_and_b32 v2, 31, v0
    v_mul_u32_u24 v3, 1280, v1
    v_lshl_add_u32 v3, v2, 3, v3
    s_mul_i32 s7, s5, 3
    s_lshl1_add_u32 s8, s5, 16
    s_cmp_lt_u32 s5, 16
    s_cselect_b32 s8, s7, s8
    s_cselect_b32 s7, 3, 2
    s_add_u32 s8, s8, s13
    s_mul_i32 s6, s4, 80
    s_add_u32 s8, s8, s6
    s_cmp_ge_u32 s13, s7
    s_cselect_b32 s8, 640, s8
    s_lshl_b32 s10, s8, 8
    s_lshl_b32 s11, s8, 1
    v_lshlrev_b32 v12, 2, v0
    s_mul_i32 s9, s13, 18176
    s_add_u32 s9, s9, 98304
    v_mov_b32 v14, 0
    v_mov_b32 v15, 99588
    ds_write_b32 v15, v14
    v_add_u32 v4, 0, v0
    v_mul_u32_u24 v5, 3277, v4
    v_lshrrev_b32 v5, 16, v5
    v_mul_u32_u24 v6, 20, v5
    v_sub_u32 v6, v4, v6
    v_lshlrev_b32 v6, 4, v6
    s_movk_i32 s6, 1280
    v_mad_u32_u24 v64, v5, s6, v6
    s_movk_i32 s6, 320
    v_mad_u32_u24 v69, v5, s6, v6
    v_add_u32 v69, 152832, v69
    v_add_u32 v4, 64, v0
    v_mul_u32_u24 v5, 3277, v4
    v_lshrrev_b32 v5, 16, v5
    v_mul_u32_u24 v6, 20, v5
    v_sub_u32 v6, v4, v6
    v_lshlrev_b32 v6, 4, v6
    s_movk_i32 s6, 1280
    v_mad_u32_u24 v65, v5, s6, v6
    s_movk_i32 s6, 320
    v_mad_u32_u24 v70, v5, s6, v6
    v_add_u32 v70, 152832, v70
    v_add_u32 v4, 128, v0
    v_mul_u32_u24 v5, 3277, v4
    v_lshrrev_b32 v5, 16, v5
    v_mul_u32_u24 v6, 20, v5
    v_sub_u32 v6, v4, v6
    v_lshlrev_b32 v6, 4, v6
    s_movk_i32 s6, 1280
    v_mad_u32_u24 v66, v5, s6, v6
    s_movk_i32 s6, 320
    v_mad_u32_u24 v71, v5, s6, v6
    v_add_u32 v71, 152832, v71
    v_add_u32 v4, 192, v0
    v_mul_u32_u24 v5, 3277, v4
    v_lshrrev_b32 v5, 16, v5
    v_mul_u32_u24 v6, 20, v5
    v_sub_u32 v6, v4, v6
    v_lshlrev_b32 v6, 4, v6
    s_movk_i32 s6, 1280
    v_mad_u32_u24 v67, v5, s6, v6
    s_movk_i32 s6, 320
    v_mad_u32_u24 v72, v5, s6, v6
    v_add_u32 v72, 152832, v72
    v_add_u32 v4, 256, v0
    v_mul_u32_u24 v5, 3277, v4
    v_lshrrev_b32 v5, 16, v5
    v_mul_u32_u24 v6, 20, v5
    v_sub_u32 v6, v4, v6
    v_lshlrev_b32 v6, 4, v6
    s_movk_i32 s6, 1280
    v_mad_u32_u24 v68, v5, s6, v6
    s_movk_i32 s6, 320
    v_mad_u32_u24 v73, v5, s6, v6
    v_add_u32 v73, 152832, v73
    s_waitcnt lgkmcnt(0)
    s_cmp_eq_u32 s3, 7
    s_cbranch_scc1 L_A7
    s_mov_b32 s52, s16
    s_mov_b32 s53, s17
    s_mov_b32 s54, 2621440
    s_mov_b32 s55, 0x20000
    buffer_load_dwordx2 v[20:21], v3, s[52:55], s15 offen offset:0
    buffer_load_dwordx2 v[22:23], v3, s[52:55], s15 offen offset:256
    buffer_load_dwordx2 v[24:25], v3, s[52:55], s15 offen offset:512
    buffer_load_dwordx2 v[26:27], v3, s[52:55], s15 offen offset:768
    buffer_load_dwordx2 v[28:29], v3, s[52:55], s15 offen offset:1024
    s_mov_b32 s56, s18
    s_mov_b32 s57, s19
    s_mov_b32 s58, 163840
    s_mov_b32 s59, 0x20000
    buffer_load_dword v4, v12, s[56:59], s10 offen nt
    s_mov_b32 s60, s20
    s_mov_b32 s61, s21
    s_mov_b32 s62, 163840
    s_mov_b32 s63, 0x20000
    buffer_load_dword v5, v12, s[60:63], s10 offen nt
    s_mov_b32 s64, s22
    s_mov_b32 s65, s23
    s_mov_b32 s66, 163840
    s_mov_b32 s67, 0x20000
    buffer_load_dword v6, v12, s[64:67], s10 offen nt
    s_mov_b32 s68, s24
    s_mov_b32 s69, s25
    s_mov_b32 s70, 163840
    s_mov_b32 s71, 0x20000
    buffer_load_dword v7, v12, s[68:71], s10 offen nt
    s_mov_b32 s56, s26
    s_mov_b32 s57, s27
    s_mov_b32 s58, 1280
    s_mov_b32 s59, 0x20000
    buffer_load_ushort v8, v14, s[56:59], s11 offen
    s_mov_b32 s60, s28
    s_mov_b32 s61, s29
    s_mov_b32 s62, 1280
    s_mov_b32 s63, 0x20000
    buffer_load_ushort v19, v14, s[60:63], s11 offen
    s_barrier
    s_mov_b32 s48, s44
    s_mov_b32 s49, s45
    s_mov_b32 s50, 16777216
    s_mov_b32 s51, 0x20000
    s_mov_b32 s72, s42
    s_mov_b32 s73, s43
    s_mov_b32 s74, 256
    s_mov_b32 s75, 0x20000
    s_waitcnt vmcnt(6)
    s_branch L_LN
L_A7:
    s_mov_b32 s48, s44
    s_mov_b32 s49, s45
    s_mov_b32 s50, 16777216
    s_mov_b32 s51, 0x20000
    s_mov_b32 s72, s42
    s_mov_b32 s73, s43
    s_mov_b32 s74, 256
    s_mov_b32 s75, 0x20000
    s_cmp_lg_u32 s2, 0
    s_cbranch_scc1 L_A1
    v_mul_u32_u24 v4, 128, v0
    v_mov_b32 v32, 0
    v_mov_b32 v33, 0
    v_mov_b32 v34, 0
    v_mov_b32 v35, 0
    s_mov_b32 s6, 0
    buffer_store_dwordx4 v[32:35], v4, s[48:51], s6 offen sc1
    s_mov_b32 s6, 8192
    buffer_store_dwordx4 v[32:35], v4, s[48:51], s6 offen sc1
    s_barrier
    s_waitcnt vmcnt(0)
    v_mov_b32 v32, 1
    s_mov_b64 exec, 1
    buffer_store_dword v32, v14, s[72:75], 0 offen sc1
    s_mov_b64 exec, -1
    s_mov_b32 s52, s16
    s_mov_b32 s53, s17
    s_mov_b32 s54, 2621440
    s_mov_b32 s55, 0x20000
    buffer_load_dwordx2 v[20:21], v3, s[52:55], s15 offen offset:0
    buffer_load_dwordx2 v[22:23], v3, s[52:55], s15 offen offset:256
    buffer_load_dwordx2 v[24:25], v3, s[52:55], s15 offen offset:512
    buffer_load_dwordx2 v[26:27], v3, s[52:55], s15 offen offset:768
    buffer_load_dwordx2 v[28:29], v3, s[52:55], s15 offen offset:1024
    s_branch L_A2
L_A1:
    s_mov_b32 s52, s16
    s_mov_b32 s53, s17
    s_mov_b32 s54, 2621440
    s_mov_b32 s55, 0x20000
    buffer_load_dwordx2 v[20:21], v3, s[52:55], s15 offen offset:0
    buffer_load_dwordx2 v[22:23], v3, s[52:55], s15 offen offset:256
    buffer_load_dwordx2 v[24:25], v3, s[52:55], s15 offen offset:512
    buffer_load_dwordx2 v[26:27], v3, s[52:55], s15 offen offset:768
    buffer_load_dwordx2 v[28:29], v3, s[52:55], s15 offen offset:1024
    s_barrier
L_A2:
    s_mov_b32 s60, s38
    s_mov_b32 s61, s39
    s_mov_b32 s62, 1280
    s_mov_b32 s63, 0x20000
    s_mov_b32 s56, s36
    s_mov_b32 s57, s37
    s_mov_b32 s58, 2211840
    s_mov_b32 s59, 0x20000
    s_lshr_b32 s6, s2, 2
    s_mul_i32 s10, s6, 40960
    s_and_b32 s7, s2, 3
    s_mul_i32 s11, s7, 320
    s_add_u32 s10, s10, s11
    s_add_u32 s11, s10, 20480
    s_waitcnt vmcnt(0)
L_LN:
    v_mul_u32_u24 v16, 1280, v1
    v_lshl_add_u32 v16, v2, 3, v16
    v_add_u32 v16, 152832, v16
    v_lshlrev_b32 v17, 5, v1
    v_add_u32 v17, 163584, v17
    v_lshlrev_b32 v32, 16, v20
    v_and_b32 v33, 0xffff0000, v20
    v_lshlrev_b32 v34, 16, v21
    v_and_b32 v35, 0xffff0000, v21
    v_lshlrev_b32 v36, 16, v22
    v_and_b32 v37, 0xffff0000, v22
    v_lshlrev_b32 v38, 16, v23
    v_and_b32 v39, 0xffff0000, v23
    v_lshlrev_b32 v40, 16, v24
    v_and_b32 v41, 0xffff0000, v24
    v_lshlrev_b32 v42, 16, v25
    v_and_b32 v43, 0xffff0000, v25
    v_lshlrev_b32 v44, 16, v26
    v_and_b32 v45, 0xffff0000, v26
    v_lshlrev_b32 v46, 16, v27
    v_and_b32 v47, 0xffff0000, v27
    v_lshlrev_b32 v48, 16, v28
    v_and_b32 v49, 0xffff0000, v28
    v_lshlrev_b32 v50, 16, v29
    v_and_b32 v51, 0xffff0000, v29
    v_add_f32 v52, v32, v33
    v_mul_f32 v54, v32, v32
    v_add_f32 v53, v34, v35
    v_mul_f32 v55, v33, v33
    v_fmac_f32 v54, v34, v34
    v_fmac_f32 v55, v35, v35
    v_add_f32 v52, v52, v36
    v_fmac_f32 v54, v36, v36
    v_add_f32 v53, v53, v37
    v_fmac_f32 v55, v37, v37
    v_add_f32 v52, v52, v38
    v_fmac_f32 v54, v38, v38
    v_add_f32 v53, v53, v39
    v_fmac_f32 v55, v39, v39
    v_add_f32 v52, v52, v40
    v_fmac_f32 v54, v40, v40
    v_add_f32 v53, v53, v41
    v_fmac_f32 v55, v41, v41
    v_add_f32 v52, v52, v42
    v_fmac_f32 v54, v42, v42
    v_add_f32 v53, v53, v43
    v_fmac_f32 v55, v43, v43
    v_add_f32 v52, v52, v44
    v_fmac_f32 v54, v44, v44
    v_add_f32 v53, v53, v45
    v_fmac_f32 v55, v45, v45
    v_add_f32 v52, v52, v46
    v_fmac_f32 v54, v46, v46
    v_add_f32 v53, v53, v47
    v_fmac_f32 v55, v47, v47
    v_add_f32 v52, v52, v48
    v_fmac_f32 v54, v48, v48
    v_add_f32 v53, v53, v49
    v_fmac_f32 v55, v49, v49
    v_add_f32 v52, v52, v50
    v_fmac_f32 v54, v50, v50
    v_add_f32 v53, v53, v51
    v_fmac_f32 v55, v51, v51
    v_add_f32 v52, v52, v53
    v_add_f32 v54, v54, v55
    s_nop 0
    v_add_f32_dpp v52, v52, v52 quad_perm:[1,0,3,2] row_mask:0xf bank_mask:0xf
    v_add_f32_dpp v54, v54, v54 quad_perm:[1,0,3,2] row_mask:0xf bank_mask:0xf
    s_nop 0
    v_add_f32_dpp v52, v52, v52 quad_perm:[2,3,0,1] row_mask:0xf bank_mask:0xf
    v_add_f32_dpp v54, v54, v54 quad_perm:[2,3,0,1] row_mask:0xf bank_mask:0xf
    s_nop 0
    v_add_f32_dpp v52, v52, v52 row_half_mirror row_mask:0xf bank_mask:0xf
    v_add_f32_dpp v54, v54, v54 row_half_mirror row_mask:0xf bank_mask:0xf
    s_nop 0
    v_add_f32_dpp v52, v52, v52 row_mirror row_mask:0xf bank_mask:0xf
    v_add_f32_dpp v54, v54, v54 row_mirror row_mask:0xf bank_mask:0xf
    ds_swizzle_b32 v53, v52 offset:0x401F
    ds_swizzle_b32 v55, v54 offset:0x401F
    s_waitcnt lgkmcnt(0)
    v_add_f32 v52, v52, v53
    v_add_f32 v54, v54, v55
    v_mul_f32 v52, 0x3acccccd, v52
    v_mul_f32 v54, 0x3acccccd, v54
    v_fma_f32 v54, -v52, v52, v54
    v_max_f32 v54, 0, v54
    v_cvt_pk_bf16_f32 v56, v52, v52
    v_and_b32 v56, 0xffff0000, v56
    v_cvt_pk_bf16_f32 v57, v54, v54
    v_and_b32 v57, 0xffff0000, v57
    v_add_f32 v57, 0x3727c5ac, v57
    v_cvt_pk_bf16_f32 v57, v57, v57
    v_and_b32 v57, 0xffff0000, v57
    v_sqrt_f32 v57, v57
    s_nop 0
    v_cvt_pk_bf16_f32 v57, v57, v57
    v_and_b32 v57, 0xffff0000, v57
    v_rcp_f32 v58, v57
    v_sub_f32 v32, v32, v56
    v_sub_f32 v33, v33, v56
    v_sub_f32 v34, v34, v56
    v_sub_f32 v35, v35, v56
    v_sub_f32 v36, v36, v56
    v_sub_f32 v37, v37, v56
    v_sub_f32 v38, v38, v56
    v_sub_f32 v39, v39, v56
    v_sub_f32 v40, v40, v56
    v_sub_f32 v41, v41, v56
    v_sub_f32 v42, v42, v56
    v_sub_f32 v43, v43, v56
    v_sub_f32 v44, v44, v56
    v_sub_f32 v45, v45, v56
    v_sub_f32 v46, v46, v56
    v_sub_f32 v47, v47, v56
    v_sub_f32 v48, v48, v56
    v_sub_f32 v49, v49, v56
    v_sub_f32 v50, v50, v56
    v_sub_f32 v51, v51, v56
    v_cvt_pk_bf16_f32 v20, v32, v33
    v_cvt_pk_bf16_f32 v21, v34, v35
    v_cvt_pk_bf16_f32 v22, v36, v37
    v_cvt_pk_bf16_f32 v23, v38, v39
    v_cvt_pk_bf16_f32 v24, v40, v41
    v_cvt_pk_bf16_f32 v25, v42, v43
    v_cvt_pk_bf16_f32 v26, v44, v45
    v_cvt_pk_bf16_f32 v27, v46, v47
    v_cvt_pk_bf16_f32 v28, v48, v49
    v_cvt_pk_bf16_f32 v29, v50, v51
    v_lshlrev_b32 v32, 16, v20
    v_and_b32 v33, 0xffff0000, v20
    v_lshlrev_b32 v34, 16, v21
    v_and_b32 v35, 0xffff0000, v21
    v_lshlrev_b32 v36, 16, v22
    v_and_b32 v37, 0xffff0000, v22
    v_lshlrev_b32 v38, 16, v23
    v_and_b32 v39, 0xffff0000, v23
    v_lshlrev_b32 v40, 16, v24
    v_and_b32 v41, 0xffff0000, v24
    v_lshlrev_b32 v42, 16, v25
    v_and_b32 v43, 0xffff0000, v25
    v_lshlrev_b32 v44, 16, v26
    v_and_b32 v45, 0xffff0000, v26
    v_lshlrev_b32 v46, 16, v27
    v_and_b32 v47, 0xffff0000, v27
    v_lshlrev_b32 v48, 16, v28
    v_and_b32 v49, 0xffff0000, v28
    v_lshlrev_b32 v50, 16, v29
    v_and_b32 v51, 0xffff0000, v29
    v_mul_f32 v32, v32, v58
    v_mul_f32 v33, v33, v58
    v_mul_f32 v34, v34, v58
    v_mul_f32 v35, v35, v58
    v_mul_f32 v36, v36, v58
    v_mul_f32 v37, v37, v58
    v_mul_f32 v38, v38, v58
    v_mul_f32 v39, v39, v58
    v_mul_f32 v40, v40, v58
    v_mul_f32 v41, v41, v58
    v_mul_f32 v42, v42, v58
    v_mul_f32 v43, v43, v58
    v_mul_f32 v44, v44, v58
    v_mul_f32 v45, v45, v58
    v_mul_f32 v46, v46, v58
    v_mul_f32 v47, v47, v58
    v_mul_f32 v48, v48, v58
    v_mul_f32 v49, v49, v58
    v_mul_f32 v50, v50, v58
    v_mul_f32 v51, v51, v58
    v_cvt_pk_bf16_f32 v20, v32, v33
    v_cvt_pk_bf16_f32 v21, v34, v35
    ds_write_b64 v16, v[20:21] offset:0
    v_cvt_pk_bf16_f32 v22, v36, v37
    v_cvt_pk_bf16_f32 v23, v38, v39
    ds_write_b64 v16, v[22:23] offset:256
    v_cvt_pk_bf16_f32 v24, v40, v41
    v_cvt_pk_bf16_f32 v25, v42, v43
    ds_write_b64 v16, v[24:25] offset:512
    v_cvt_pk_bf16_f32 v26, v44, v45
    v_cvt_pk_bf16_f32 v27, v46, v47
    ds_write_b64 v16, v[26:27] offset:768
    v_cvt_pk_bf16_f32 v28, v48, v49
    v_cvt_pk_bf16_f32 v29, v50, v51
    ds_write_b64 v16, v[28:29] offset:1024
    v_sub_f32 v59, v52, v56
    v_mul_f32 v59, v59, v58
    v_mul_f32 v60, v54, v58
    v_mul_f32 v60, v60, v58
    v_cvt_pk_bf16_f32 v59, v59, v59
    v_and_b32 v59, 0xffff0000, v59
    v_cvt_pk_bf16_f32 v61, v60, v60
    v_and_b32 v61, 0xffff0000, v61
    v_add_f32 v61, 0x3727c5ac, v61
    v_cvt_pk_bf16_f32 v61, v61, v61
    v_and_b32 v61, 0xffff0000, v61
    v_sqrt_f32 v61, v61
    s_nop 0
    v_cvt_pk_bf16_f32 v61, v61, v61
    v_and_b32 v61, 0xffff0000, v61
    v_mul_f32 v46, v57, v61
    v_fma_f32 v63, -v59, v57, -v56
    v_rcp_f32 v62, v46
    v_mov_b32 v47, 0
    v_cvt_pk_bf16_f32 v32, v46, v46
    v_and_b32 v32, 0xffff0000, v32
    v_cvt_pk_bf16_f32 v33, v63, v63
    v_and_b32 v33, 0xffff0000, v33
    v_sub_f32 v32, v46, v32
    v_sub_f32 v33, v63, v33
    v_mul_f32 v44, v62, v62
    v_cvt_pk_bf16_f32 v34, v33, v33
    v_and_b32 v34, 0xffff0000, v34
    v_cvt_pk_bf16_f32 v40, v46, v32
    v_cvt_pk_bf16_f32 v41, v63, v33
    v_sub_f32 v34, v33, v34
    v_mov_b32 v42, v41
    v_cvt_pk_bf16_f32 v43, v34, v63
    v_mul_f32 v45, 0xc0135761, v62
    v_mul_f32 v44, 0x3d372713, v44
    v_mul_f32 v44, v44, v45
    s_mov_b32 s0, 1
    s_mov_b32 s1, 1
    s_mov_b64 exec, s[0:1]
    ds_write_b128 v17, v[40:43]
    ds_write_b128 v17, v[44:47] offset:16
    s_mov_b64 exec, -1
    v_mov_b32 v61, 1
    ds_write_b32 v9, v61
    s_cmp_eq_u32 s3, 7
    s_cbranch_scc1 L_S
    s_cmp_ge_u32 s8, 640
    s_cbranch_scc1 L_END
    s_waitcnt vmcnt(0)
    v_lshlrev_b32 v8, 16, v8
    v_mul_f32 v8, 1069066811, v8
    v_exp_f32 v8, v8
    v_lshlrev_b32 v84, 16, v4
    v_lshlrev_b32 v85, 16, v5
    v_lshlrev_b32 v88, 16, v6
    v_lshlrev_b32 v89, 16, v7
    v_and_b32 v86, 0xffff0000, v4
    v_and_b32 v87, 0xffff0000, v5
    v_and_b32 v90, 0xffff0000, v6
    v_and_b32 v91, 0xffff0000, v7
    v_cvt_pk_bf16_f32 v8, v8, v8
    v_and_b32 v8, 0xffff0000, v8
    v_mul_f32 v84, 1069066811, v84
    v_mul_f32 v86, 1069066811, v86
    v_exp_f32 v84, v84
    v_exp_f32 v86, v86
    v_add_f32 v4, v8, v8
    v_cvt_pk_bf16_f32 v84, v84, v84
    v_and_b32 v84, 0xffff0000, v84
    v_cvt_pk_bf16_f32 v86, v86, v86
    v_and_b32 v86, 0xffff0000, v86
    v_mul_f32 v84, v84, v8
    v_mul_f32 v85, v85, v8
    v_mul_f32 v88, v88, v4
    v_mul_f32 v89, v89, v4
    v_mul_f32 v86, v86, v8
    v_mul_f32 v87, v87, v8
    v_mul_f32 v90, v90, v4
    v_mul_f32 v91, v91, v4
    v_mul_f32 v84, 0xbfb8aa3b, v84
    v_mul_f32 v85, 1042479491, v85
    v_mul_f32 v86, 0xbfb8aa3b, v86
    v_mul_f32 v87, 1042479491, v87
    v_mul_f32 v64, 0x40000000, v84
    v_mul_f32 v65, 0x40000000, v85
    v_mul_f32 v66, 0x40000000, v86
    v_mul_f32 v67, 0x40000000, v87
    v_mul_f32 v68, 0x42000000, v84
    v_mul_f32 v69, 0x42000000, v85
    v_mul_f32 v70, 0x42000000, v86
    v_mul_f32 v71, 0x42000000, v87
    v_exp_f32 v72, v84
    v_fract_f32 v73, v85
    v_exp_f32 v74, v86
    v_fract_f32 v75, v87
    v_mul_f32 v76, 0x45000000, v84
    v_mul_f32 v77, 0x45000000, v85
    v_mul_f32 v78, 0x45000000, v86
    v_mul_f32 v79, 0x45000000, v87
    v_exp_f32 v64, v64
    v_fract_f32 v65, v65
    v_exp_f32 v66, v66
    v_fract_f32 v67, v67
    v_exp_f32 v68, v68
    v_fract_f32 v69, v69
    v_exp_f32 v70, v70
    v_fract_f32 v71, v71
    v_exp_f32 v76, v76
    v_fract_f32 v77, v77
    v_exp_f32 v78, v78
    v_fract_f32 v79, v79
    v_cos_f32 v192, v65
    v_sin_f32 v193, v65
    v_cos_f32 v194, v67
    v_sin_f32 v195, v67
    v_cos_f32 v196, v69
    v_sin_f32 v197, v69
    v_cos_f32 v198, v71
    v_sin_f32 v199, v71
    v_cos_f32 v200, v73
    v_sin_f32 v201, v73
    v_cos_f32 v202, v75
    v_sin_f32 v203, v75
    v_cos_f32 v204, v77
    v_sin_f32 v205, v77
    v_cos_f32 v206, v79
    v_sin_f32 v207, v79
    v_mul_f32 v192, v192, v64
    v_mul_f32 v193, -v193, v64
    v_mul_f32 v194, v194, v66
    v_mul_f32 v195, -v195, v66
    v_mul_f32 v196, v196, v68
    v_mul_f32 v197, v197, v68
    v_mul_f32 v198, v198, v70
    v_mul_f32 v199, v199, v70
    v_mul_f32 v200, v200, v72
    v_mul_f32 v201, v201, v72
    v_mul_f32 v202, v202, v74
    v_mul_f32 v203, v203, v74
    v_mul_f32 v204, v204, v76
    v_mul_f32 v205, v205, v76
    v_mul_f32 v206, v206, v78
    v_mul_f32 v207, v207, v78
    v_mul_f32 v64, v201, v89
    v_mul_f32 v65, v203, v91
    v_mul_f32 v66, v205, v89
    v_mul_f32 v67, v207, v91
    v_mul_f32 v201, v201, v88
    v_mul_f32 v203, v203, v90
    v_mul_f32 v205, v205, v88
    v_mul_f32 v207, v207, v90
    v_fmac_f32 v201, v200, v89
    v_fmac_f32 v203, v202, v91
    v_fmac_f32 v205, v204, v89
    v_fmac_f32 v207, v206, v91
    v_fma_f32 v200, v200, v88, -v64
    v_fma_f32 v202, v202, v90, -v65
    v_fma_f32 v204, v204, v88, -v66
    v_fma_f32 v206, v206, v90, -v67
    v_and_b32 v10, 15, v0
    v_lshrrev_b32 v11, 4, v0
    v_lshlrev_b32 v12, 3, v0
    s_add_u32 s6, s9, 1296
    v_add_u32 v12, s6, v12
    v_mul_u32_u24 v14, 528, v10
    v_lshl_add_u32 v14, v11, 4, v14
    v_add_u32 v14, s6, v14
    v_mov_b32 v80, 1.0
    v_mov_b32 v81, 0
    v_mov_b32 v82, 1.0
    v_mov_b32 v83, 0
    s_mov_b32 s10, 4
    v_add_u32 v13, 0, v12
KL_43:
    v_cvt_pk_bf16_f32 v64, v80, v81
    v_cvt_pk_bf16_f32 v65, v82, v83
    v_cvt_pk_bf16_f32 v66, v88, v89
    v_cvt_pk_bf16_f32 v67, v90, v91
    v_mul_f32 v72, v81, v193
    v_mul_f32 v73, v83, v195
    v_mul_f32 v74, v89, v197
    v_mul_f32 v75, v91, v199
    ds_write_b64 v13, v[64:65] offset:0
    ds_write_b64 v13, v[66:67] offset:8448
    v_mul_f32 v81, v81, v192
    v_mul_f32 v83, v83, v194
    v_mul_f32 v89, v89, v196
    v_mul_f32 v91, v91, v198
    v_fmac_f32 v81, v80, v193
    v_fmac_f32 v83, v82, v195
    v_fmac_f32 v89, v88, v197
    v_fmac_f32 v91, v90, v199
    v_fma_f32 v80, v80, v192, -v72
    v_fma_f32 v82, v82, v194, -v73
    v_fma_f32 v88, v88, v196, -v74
    v_fma_f32 v90, v90, v198, -v75
    v_cvt_pk_bf16_f32 v68, v80, v81
    v_cvt_pk_bf16_f32 v69, v82, v83
    v_cvt_pk_bf16_f32 v70, v88, v89
    v_cvt_pk_bf16_f32 v71, v90, v91
    v_mul_f32 v72, v81, v193
    v_mul_f32 v73, v83, v195
    v_mul_f32 v74, v89, v197
    v_mul_f32 v75, v91, v199
    ds_write_b64 v13, v[68:69] offset:528
    ds_write_b64 v13, v[70:71] offset:8976
    v_mul_f32 v81, v81, v192
    v_mul_f32 v83, v83, v194
    v_mul_f32 v89, v89, v196
    v_mul_f32 v91, v91, v198
    v_fmac_f32 v81, v80, v193
    v_fmac_f32 v83, v82, v195
    v_fmac_f32 v89, v88, v197
    v_fmac_f32 v91, v90, v199
    v_fma_f32 v80, v80, v192, -v72
    v_fma_f32 v82, v82, v194, -v73
    v_fma_f32 v88, v88, v196, -v74
    v_fma_f32 v90, v90, v198, -v75
    v_cvt_pk_bf16_f32 v64, v80, v81
    v_cvt_pk_bf16_f32 v65, v82, v83
    v_cvt_pk_bf16_f32 v66, v88, v89
    v_cvt_pk_bf16_f32 v67, v90, v91
    v_mul_f32 v72, v81, v193
    v_mul_f32 v73, v83, v195
    v_mul_f32 v74, v89, v197
    v_mul_f32 v75, v91, v199
    ds_write_b64 v13, v[64:65] offset:1056
    ds_write_b64 v13, v[66:67] offset:9504
    v_mul_f32 v81, v81, v192
    v_mul_f32 v83, v83, v194
    v_mul_f32 v89, v89, v196
    v_mul_f32 v91, v91, v198
    v_fmac_f32 v81, v80, v193
    v_fmac_f32 v83, v82, v195
    v_fmac_f32 v89, v88, v197
    v_fmac_f32 v91, v90, v199
    v_fma_f32 v80, v80, v192, -v72
    v_fma_f32 v82, v82, v194, -v73
    v_fma_f32 v88, v88, v196, -v74
    v_fma_f32 v90, v90, v198, -v75
    v_cvt_pk_bf16_f32 v68, v80, v81
    v_cvt_pk_bf16_f32 v69, v82, v83
    v_cvt_pk_bf16_f32 v70, v88, v89
    v_cvt_pk_bf16_f32 v71, v90, v91
    v_mul_f32 v72, v81, v193
    v_mul_f32 v73, v83, v195
    v_mul_f32 v74, v89, v197
    v_mul_f32 v75, v91, v199
    ds_write_b64 v13, v[68:69] offset:1584
    ds_write_b64 v13, v[70:71] offset:10032
    v_mul_f32 v81, v81, v192
    v_mul_f32 v83, v83, v194
    v_mul_f32 v89, v89, v196
    v_mul_f32 v91, v91, v198
    v_add_u32 v13, 2112, v13
    v_fmac_f32 v81, v80, v193
    v_fmac_f32 v83, v82, v195
    v_fmac_f32 v89, v88, v197
    v_fmac_f32 v91, v90, v199
    s_sub_u32 s10, s10, 1
    s_cmp_lg_u32 s10, 0
    v_fma_f32 v80, v80, v192, -v72
    v_fma_f32 v82, v82, v194, -v73
    v_fma_f32 v88, v88, v196, -v74
    v_fma_f32 v90, v90, v198, -v75
    s_cbranch_scc1 KL_43
    ds_read_b128 v[128:131], v14 offset:0
    ds_read_b128 v[132:135], v14 offset:64
    ds_read_b128 v[136:139], v14 offset:128
    ds_read_b128 v[140:143], v14 offset:192
    ds_read_b128 v[144:147], v14 offset:256
    ds_read_b128 v[148:151], v14 offset:320
    ds_read_b128 v[152:155], v14 offset:384
    ds_read_b128 v[156:159], v14 offset:448
    ds_read_b128 v[160:163], v14 offset:8448
    ds_read_b128 v[164:167], v14 offset:8512
    ds_read_b128 v[168:171], v14 offset:8576
    ds_read_b128 v[172:175], v14 offset:8640
    ds_read_b128 v[176:179], v14 offset:8704
    ds_read_b128 v[180:183], v14 offset:8768
    ds_read_b128 v[184:187], v14 offset:8832
    ds_read_b128 v[188:191], v14 offset:8896
    v_cvt_pk_bf16_f32 v76, v204, v205
    v_cvt_pk_bf16_f32 v77, v206, v207
    ds_write_b64 v12, v[76:77] offset:12672
    s_mov_b32 s10, 2
    v_add_u32 v13, 8448, v12
KL_44:
    v_cvt_pk_bf16_f32 v64, v200, v201
    v_cvt_pk_bf16_f32 v65, v202, v203
    v_mul_f32 v72, v201, v197
    v_mul_f32 v73, v203, v199
    ds_write_b64 v13, v[64:65] offset:0
    v_mul_f32 v201, v201, v196
    v_mul_f32 v203, v203, v198
    v_fmac_f32 v201, v200, v197
    v_fmac_f32 v203, v202, v199
    v_fma_f32 v200, v200, v196, -v72
    v_fma_f32 v202, v202, v198, -v73
    v_cvt_pk_bf16_f32 v68, v200, v201
    v_cvt_pk_bf16_f32 v69, v202, v203
    v_mul_f32 v72, v201, v197
    v_mul_f32 v73, v203, v199
    ds_write_b64 v13, v[68:69] offset:528
    v_mul_f32 v201, v201, v196
    v_mul_f32 v203, v203, v198
    v_fmac_f32 v201, v200, v197
    v_fmac_f32 v203, v202, v199
    v_fma_f32 v200, v200, v196, -v72
    v_fma_f32 v202, v202, v198, -v73
    v_cvt_pk_bf16_f32 v64, v200, v201
    v_cvt_pk_bf16_f32 v65, v202, v203
    v_mul_f32 v72, v201, v197
    v_mul_f32 v73, v203, v199
    ds_write_b64 v13, v[64:65] offset:1056
    v_mul_f32 v201, v201, v196
    v_mul_f32 v203, v203, v198
    v_fmac_f32 v201, v200, v197
    v_fmac_f32 v203, v202, v199
    v_fma_f32 v200, v200, v196, -v72
    v_fma_f32 v202, v202, v198, -v73
    v_cvt_pk_bf16_f32 v68, v200, v201
    v_cvt_pk_bf16_f32 v69, v202, v203
    v_mul_f32 v72, v201, v197
    v_mul_f32 v73, v203, v199
    ds_write_b64 v13, v[68:69] offset:1584
    v_mul_f32 v201, v201, v196
    v_mul_f32 v203, v203, v198
    v_add_u32 v13, 2112, v13
    v_fmac_f32 v201, v200, v197
    v_fmac_f32 v203, v202, v199
    s_sub_u32 s10, s10, 1
    s_cmp_lg_u32 s10, 0
    v_fma_f32 v200, v200, v196, -v72
    v_fma_f32 v202, v202, v198, -v73
    s_cbranch_scc1 KL_44
    ds_read_b128 v[208:211], v14 offset:8448
    ds_read_b128 v[212:215], v14 offset:8512
    ds_read_b128 v[216:219], v14 offset:8576
    ds_read_b128 v[220:223], v14 offset:8640
    ds_read_b128 v[224:227], v14 offset:8704
    ds_read_b128 v[228:231], v14 offset:8768
    ds_read_b128 v[232:235], v14 offset:8832
    ds_read_b128 v[236:239], v14 offset:8896
    s_waitcnt lgkmcnt(8)
    v_mfma_f32_16x16x32_bf16 v[112:115], v[160:163], v[128:131], 0
    v_mfma_f32_16x16x32_bf16 v[112:115], v[164:167], v[132:135], v[112:115]
    v_mfma_f32_16x16x32_bf16 v[112:115], v[168:171], v[136:139], v[112:115]
    v_mfma_f32_16x16x32_bf16 v[112:115], v[172:175], v[140:143], v[112:115]
    v_mfma_f32_16x16x32_bf16 v[112:115], v[176:179], v[144:147], v[112:115]
    v_mfma_f32_16x16x32_bf16 v[112:115], v[180:183], v[148:151], v[112:115]
    v_mfma_f32_16x16x32_bf16 v[112:115], v[184:187], v[152:155], v[112:115]
    v_mfma_f32_16x16x32_bf16 v[112:115], v[188:191], v[156:159], v[112:115]
    s_add_u32 s10, s9, 0
    v_lshlrev_b32 v20, 2, v10
    v_lshl_add_u32 v20, v11, 8, v20
    v_add_u32 v20, s10, v20
    v_lshlrev_b32 v21, 1, v10
    v_lshl_add_u32 v21, v11, 7, v21
    v_add_u32 v21, s10, v21
    v_subrev_u32 v15, 256, v9
    s_waitcnt lgkmcnt(7)
    v_mfma_f32_16x16x32_bf16 v[116:119], v[208:211], v[128:131], 0
    s_waitcnt lgkmcnt(6)
    v_mfma_f32_16x16x32_bf16 v[116:119], v[212:215], v[132:135], v[116:119]
    s_waitcnt lgkmcnt(5)
    v_mfma_f32_16x16x32_bf16 v[116:119], v[216:219], v[136:139], v[116:119]
    s_waitcnt lgkmcnt(4)
    v_mfma_f32_16x16x32_bf16 v[116:119], v[220:223], v[140:143], v[116:119]
    s_waitcnt lgkmcnt(3)
    v_mfma_f32_16x16x32_bf16 v[116:119], v[224:227], v[144:147], v[116:119]
    s_waitcnt lgkmcnt(2)
    v_mfma_f32_16x16x32_bf16 v[116:119], v[228:231], v[148:151], v[116:119]
    s_waitcnt lgkmcnt(1)
    v_mfma_f32_16x16x32_bf16 v[116:119], v[232:235], v[152:155], v[116:119]
    s_waitcnt lgkmcnt(0)
    v_mfma_f32_16x16x32_bf16 v[116:119], v[236:239], v[156:159], v[116:119]
    s_nop 7
    v_cvt_pk_bf16_f32 v24, v112, v116
    v_cvt_pk_bf16_f32 v25, v113, v117
    v_cvt_pk_bf16_f32 v26, v114, v118
    v_cvt_pk_bf16_f32 v27, v115, v119
    s_mov_b32 exec_hi, 0
    ds_write_b32 v20, v24 offset:0
    ds_write_b32 v20, v25 offset:64
    ds_write_b32 v20, v26 offset:128
    ds_write_b32 v20, v27 offset:192
    s_mov_b32 exec_lo, 0
    s_mov_b32 exec_hi, -1
    ds_write_b16 v21, v24 offset:256
    ds_write_b16 v21, v25 offset:288
    ds_write_b16 v21, v26 offset:320
    ds_write_b16 v21, v27 offset:352
    s_mov_b32 exec_hi, 1
    ds_write_b16_d16_hi v21, v24 offset:1024
    s_mov_b64 exec, -1
    ds_read_b32 v17, v15
    s_waitcnt lgkmcnt(0)
    v_cmp_gt_u32 vcc, 1, v17
    s_nop 0
    s_cbranch_vccnz SPIN_45
BACK_46:
    v_lshlrev_b32 v24, 1, v0
    v_sub_u32 v22, 2047, v24
    v_sub_u32 v23, 2046, v24
    v_cvt_f32_i32 v22, v22
    v_cvt_f32_i32 v23, v23
    v_lshlrev_b32 v21, 2, v0
    s_add_u32 s6, s9, 1300
    v_add_u32 v21, s6, v21
    s_add_u32 s6, s9, 0
    s_sub_u32 s7, s6, 34048
    v_mov_b32 v26, s7
    v_mov_b32 v30, 0xc3000000
    v_lshlrev_b32 v27, 1, v24
    v_sub_u32 v27, s6, v27
    v_mov_b32 v28, 0
    s_mov_b32 s10, 3
L_EXP:
    v_cvt_pk_bf16_f32 v32, v22, v23
    v_add_f32 v22, v22, v30
    v_add_f32 v23, v23, v30
    v_mad_u32_u16 v33, v32, 2, v26
    v_mad_u32_u16 v34, v32, 2, v26 op_sel:[1,0,0,0]
    ds_read_u16 v33, v33
    ds_read_u16 v34, v34
    v_cvt_pk_bf16_f32 v36, v22, v23
    v_add_f32 v22, v22, v30
    v_add_f32 v23, v23, v30
    v_mad_u32_u16 v37, v36, 2, v26
    v_mad_u32_u16 v38, v36, 2, v26 op_sel:[1,0,0,0]
    ds_read_u16 v37, v37
    ds_read_u16 v38, v38
    v_cvt_pk_bf16_f32 v40, v22, v23
    v_add_f32 v22, v22, v30
    v_add_f32 v23, v23, v30
    v_mad_u32_u16 v41, v40, 2, v26
    v_mad_u32_u16 v42, v40, 2, v26 op_sel:[1,0,0,0]
    ds_read_u16 v41, v41
    ds_read_u16 v42, v42
    v_cvt_pk_bf16_f32 v44, v22, v23
    v_add_f32 v22, v22, v30
    v_add_f32 v23, v23, v30
    v_mad_u32_u16 v45, v44, 2, v26
    v_mad_u32_u16 v46, v44, 2, v26 op_sel:[1,0,0,0]
    ds_read_u16 v45, v45
    ds_read_u16 v46, v46
    s_waitcnt lgkmcnt(6)
    v_lshl_or_b32 v32, v34, 16, v33
    ds_write_b32 v21, v32 offset:0
    ds_write_b32 v21, v32 offset:4164
    ds_write_b32 v21, v32 offset:8328
    ds_write_b32 v21, v32 offset:12492
    s_waitcnt lgkmcnt(8)
    v_lshl_or_b32 v36, v38, 16, v37
    ds_write_b32 v21, v36 offset:256
    ds_write_b32 v21, v36 offset:4420
    ds_write_b32 v21, v36 offset:8584
    ds_write_b32 v21, v36 offset:12748
    s_waitcnt lgkmcnt(10)
    v_lshl_or_b32 v40, v42, 16, v41
    ds_write_b32 v21, v40 offset:512
    ds_write_b32 v21, v40 offset:4676
    ds_write_b32 v21, v40 offset:8840
    ds_write_b32 v21, v40 offset:13004
    s_waitcnt lgkmcnt(12)
    v_lshl_or_b32 v44, v46, 16, v45
    ds_write_b32 v21, v44 offset:768
    ds_write_b32 v21, v44 offset:4932
    ds_write_b32 v21, v44 offset:9096
    ds_write_b32 v21, v44 offset:13260
    v_add_u32 v21, 1024, v21
    s_sub_u32 s10, s10, 1
    s_cmp_lg_u32 s10, 0
    s_waitcnt lgkmcnt(0)
    s_cbranch_scc1 L_EXP
    v_cvt_pk_bf16_f32 v32, v22, v23
    v_add_f32 v22, v22, v30
    v_add_f32 v23, v23, v30
    v_mad_u32_u16 v33, v32, 2, v26
    v_mad_u32_u16 v34, v32, 2, v26 op_sel:[1,0,0,0]
    ds_read_u16 v33, v33
    ds_read_u16 v34, v34
    v_cvt_pk_bf16_f32 v36, v22, v23
    v_add_f32 v22, v22, v30
    v_add_f32 v23, v23, v30
    v_mad_u32_u16 v37, v36, 2, v26
    v_mad_u32_u16 v38, v36, 2, v26 op_sel:[1,0,0,0]
    ds_read_u16 v37, v37
    ds_read_u16 v38, v38
    v_cvt_pk_bf16_f32 v40, v22, v23
    v_add_f32 v22, v22, v30
    v_add_f32 v23, v23, v30
    v_mad_u32_u16 v41, v40, 2, v26
    v_mad_u32_u16 v42, v40, 2, v26 op_sel:[1,0,0,0]
    ds_read_u16 v41, v41
    ds_read_u16 v42, v42
    ds_read_u16 v45, v27 offset:254
    ds_read_u16 v46, v27 offset:252
    s_waitcnt lgkmcnt(6)
    v_lshl_or_b32 v32, v34, 16, v33
    ds_write_b32 v21, v32 offset:0
    ds_write_b32 v21, v32 offset:4164
    ds_write_b32 v21, v32 offset:8328
    ds_write_b32 v21, v32 offset:12492
    s_waitcnt lgkmcnt(8)
    v_lshl_or_b32 v36, v38, 16, v37
    ds_write_b32 v21, v36 offset:256
    ds_write_b32 v21, v36 offset:4420
    ds_write_b32 v21, v36 offset:8584
    ds_write_b32 v21, v36 offset:12748
    s_waitcnt lgkmcnt(10)
    v_lshl_or_b32 v40, v42, 16, v41
    ds_write_b32 v21, v40 offset:512
    ds_write_b32 v21, v40 offset:4676
    ds_write_b32 v21, v40 offset:8840
    ds_write_b32 v21, v40 offset:13004
    s_waitcnt lgkmcnt(12)
    v_lshl_or_b32 v44, v46, 16, v45
    ds_write_b32 v21, v44 offset:768
    ds_write_b32 v21, v44 offset:4932
    ds_write_b32 v21, v44 offset:9096
    ds_write_b32 v21, v44 offset:13260
    s_mov_b64 exec, 0x7fff
    ds_write_b32 v21, v28 offset:1024
    ds_write_b32 v21, v28 offset:5188
    ds_write_b32 v21, v28 offset:9352
    ds_write_b32 v21, v28 offset:13516
    s_mov_b64 exec, -1
    v_mov_b32 v28, 2
    ds_write_b32 v9, v28
    s_mul_i32 s11, s13, 9152
    s_add_u32 s11, s11, 61440
    v_mov_b32 v18, 163520
    v_lshrrev_b32 v12, 1, v10
    v_lshlrev_b32 v12, 6, v12
    v_lshl_add_u32 v12, v11, 4, v12
    v_and_b32 v13, 1, v10
    v_xor_b32 v13, 1, v13
    v_mul_u32_u24 v13, 4576, v13
    v_add_u32 v12, v12, v13
    s_add_u32 s6, s11, 448
    v_add_u32 v12, s6, v12
    v_and_b32 v13, 3, v10
    v_mul_u32_u24 v13, 4160, v13
    v_lshrrev_b32 v14, 2, v10
    v_sub_u32 v14, v11, v14
    v_lshl_add_u32 v13, v14, 4, v13
    s_add_u32 s6, s9, 1808
    v_add_u32 v13, s6, v13
    v_mov_b32 v20, 0
    v_mov_b32 v21, 0
    v_mov_b32 v22, 0
    v_mov_b32 v23, 0
    v_mov_b32 v24, 0
    v_mov_b32 v25, 0
    v_mov_b32 v26, 0
    v_mov_b32 v27, 0
    v_mov_b32 v28, 0
    v_mov_b32 v29, 0
    v_mov_b32 v30, 0
    v_mov_b32 v31, 0
    v_mov_b32 v32, 0
    v_mov_b32 v33, 0
    v_mov_b32 v34, 0
    v_mov_b32 v35, 0
    v_mov_b32 v36, 0
    v_mov_b32 v37, 0
    v_mov_b32 v38, 0
    v_mov_b32 v39, 0
    v_mov_b32 v40, 0
    v_mov_b32 v41, 0
    v_mov_b32 v42, 0
    v_mov_b32 v43, 0
    v_mov_b32 v44, 0
    v_mov_b32 v45, 0
    v_mov_b32 v46, 0
    v_mov_b32 v47, 0
    v_mov_b32 v48, 0
    v_mov_b32 v49, 0
    v_mov_b32 v50, 0
    v_mov_b32 v51, 0
    v_lshlrev_b32 v3, 4, v0
    v_add_u32 v3, s11, v3
    ds_read_b32 v17, v18
    s_waitcnt lgkmcnt(0)
    v_cmp_gt_u32 vcc, 3, v17
    s_nop 0
    s_cbranch_vccnz SPIN_47
BACK_48:
    ds_read_b32 v115, v3 offset:444
    ds_read_b128 v[136:139], v3 offset:448
    ds_read_b32 v120, v3 offset:1468
    ds_read_b128 v[140:143], v3 offset:1472
    ds_read_b32 v125, v3 offset:2492
    ds_read_b128 v[144:147], v3 offset:2496
    ds_read_b32 v130, v3 offset:3516
    ds_read_b128 v[148:151], v3 offset:3520
    s_waitcnt lgkmcnt(6)
    v_alignbit_b32 v152, v136, v115, 16
    v_alignbit_b32 v153, v137, v136, 16
    v_alignbit_b32 v154, v138, v137, 16
    v_alignbit_b32 v155, v139, v138, 16
    ds_write_b128 v3, v[152:155] offset:5024
    s_waitcnt lgkmcnt(5)
    v_alignbit_b32 v156, v140, v120, 16
    v_alignbit_b32 v157, v141, v140, 16
    v_alignbit_b32 v158, v142, v141, 16
    v_alignbit_b32 v159, v143, v142, 16
    ds_write_b128 v3, v[156:159] offset:6048
    s_waitcnt lgkmcnt(4)
    v_alignbit_b32 v160, v144, v125, 16
    v_alignbit_b32 v161, v145, v144, 16
    v_alignbit_b32 v162, v146, v145, 16
    v_alignbit_b32 v163, v147, v146, 16
    ds_write_b128 v3, v[160:163] offset:7072
    s_waitcnt lgkmcnt(3)
    v_alignbit_b32 v164, v148, v130, 16
    v_alignbit_b32 v165, v149, v148, 16
    v_alignbit_b32 v166, v150, v149, 16
    v_alignbit_b32 v167, v151, v150, 16
    ds_write_b128 v3, v[164:167] offset:8096
    s_waitcnt lgkmcnt(0)
    ds_read_b128 v[52:55], v12 offset:0
    ds_read_b128 v[84:87], v13 offset:3584
    ds_read_b128 v[56:59], v12 offset:512
    ds_read_b128 v[88:91], v13 offset:3072
    ds_read_b128 v[60:63], v12 offset:1024
    ds_read_b128 v[92:95], v13 offset:2560
    ds_read_b128 v[64:67], v12 offset:1536
    ds_read_b128 v[96:99], v13 offset:2048
    ds_read_b128 v[68:71], v12 offset:2048
    ds_read_b128 v[100:103], v13 offset:1536
    ds_read_b128 v[72:75], v12 offset:2560
    ds_read_b128 v[104:107], v13 offset:1024
    ds_read_b128 v[76:79], v12 offset:3072
    ds_read_b128 v[108:111], v13 offset:512
    ds_read_b128 v[80:83], v12 offset:3584
    ds_read_b128 v[112:115], v13 offset:0
    v_subrev_u32 v12, 64, v12
    v_subrev_u32 v13, 64, v13
    ds_read_b32 v17, v15
    s_waitcnt lgkmcnt(0)
    v_cmp_gt_u32 vcc, 12, v17
    s_nop 0
    s_cbranch_vccnz SPIN_49
BACK_50:
    s_setprio 1
    s_mov_b32 s10, 4
L_CV:
    s_waitcnt lgkmcnt(0)
    v_mfma_f32_16x16x32_bf16 v[20:23], v[52:55], v[84:87], v[20:23]
    ds_read_b128 v[116:119], v12 offset:0
    v_mfma_f32_16x16x32_bf16 v[24:27], v[56:59], v[84:87], v[24:27]
    ds_read_b128 v[148:151], v13 offset:3584
    v_mfma_f32_16x16x32_bf16 v[28:31], v[60:63], v[84:87], v[28:31]
    ds_read_b128 v[120:123], v12 offset:512
    v_mfma_f32_16x16x32_bf16 v[32:35], v[64:67], v[84:87], v[32:35]
    ds_read_b128 v[152:155], v13 offset:3072
    v_mfma_f32_16x16x32_bf16 v[36:39], v[68:71], v[84:87], v[36:39]
    ds_read_b128 v[124:127], v12 offset:1024
    v_mfma_f32_16x16x32_bf16 v[40:43], v[72:75], v[84:87], v[40:43]
    ds_read_b128 v[156:159], v13 offset:2560
    v_mfma_f32_16x16x32_bf16 v[44:47], v[76:79], v[84:87], v[44:47]
    ds_read_b128 v[128:131], v12 offset:1536
    v_mfma_f32_16x16x32_bf16 v[48:51], v[80:83], v[84:87], v[48:51]
    ds_read_b128 v[160:163], v13 offset:2048
    v_mfma_f32_16x16x32_bf16 v[24:27], v[52:55], v[88:91], v[24:27]
    ds_read_b128 v[132:135], v12 offset:2048
    v_mfma_f32_16x16x32_bf16 v[28:31], v[56:59], v[88:91], v[28:31]
    ds_read_b128 v[164:167], v13 offset:1536
    v_mfma_f32_16x16x32_bf16 v[32:35], v[60:63], v[88:91], v[32:35]
    ds_read_b128 v[136:139], v12 offset:2560
    v_mfma_f32_16x16x32_bf16 v[36:39], v[64:67], v[88:91], v[36:39]
    ds_read_b128 v[168:171], v13 offset:1024
    v_mfma_f32_16x16x32_bf16 v[40:43], v[68:71], v[88:91], v[40:43]
    ds_read_b128 v[140:143], v12 offset:3072
    v_mfma_f32_16x16x32_bf16 v[44:47], v[72:75], v[88:91], v[44:47]
    ds_read_b128 v[172:175], v13 offset:512
    v_mfma_f32_16x16x32_bf16 v[48:51], v[76:79], v[88:91], v[48:51]
    ds_read_b128 v[144:147], v12 offset:3584
    v_mfma_f32_16x16x32_bf16 v[28:31], v[52:55], v[92:95], v[28:31]
    ds_read_b128 v[176:179], v13 offset:0
    v_mfma_f32_16x16x32_bf16 v[32:35], v[56:59], v[92:95], v[32:35]
    v_subrev_u32 v12, 64, v12
    v_subrev_u32 v13, 64, v13
    v_mfma_f32_16x16x32_bf16 v[36:39], v[60:63], v[92:95], v[36:39]
    v_mfma_f32_16x16x32_bf16 v[40:43], v[64:67], v[92:95], v[40:43]
    v_mfma_f32_16x16x32_bf16 v[44:47], v[68:71], v[92:95], v[44:47]
    v_mfma_f32_16x16x32_bf16 v[48:51], v[72:75], v[92:95], v[48:51]
    v_mfma_f32_16x16x32_bf16 v[32:35], v[52:55], v[96:99], v[32:35]
    v_mfma_f32_16x16x32_bf16 v[36:39], v[56:59], v[96:99], v[36:39]
    v_mfma_f32_16x16x32_bf16 v[40:43], v[60:63], v[96:99], v[40:43]
    v_mfma_f32_16x16x32_bf16 v[44:47], v[64:67], v[96:99], v[44:47]
    v_mfma_f32_16x16x32_bf16 v[48:51], v[68:71], v[96:99], v[48:51]
    v_mfma_f32_16x16x32_bf16 v[36:39], v[52:55], v[100:103], v[36:39]
    v_mfma_f32_16x16x32_bf16 v[40:43], v[56:59], v[100:103], v[40:43]
    v_mfma_f32_16x16x32_bf16 v[44:47], v[60:63], v[100:103], v[44:47]
    v_mfma_f32_16x16x32_bf16 v[48:51], v[64:67], v[100:103], v[48:51]
    v_mfma_f32_16x16x32_bf16 v[40:43], v[52:55], v[104:107], v[40:43]
    v_mfma_f32_16x16x32_bf16 v[44:47], v[56:59], v[104:107], v[44:47]
    v_mfma_f32_16x16x32_bf16 v[48:51], v[60:63], v[104:107], v[48:51]
    v_mfma_f32_16x16x32_bf16 v[44:47], v[52:55], v[108:111], v[44:47]
    v_mfma_f32_16x16x32_bf16 v[48:51], v[56:59], v[108:111], v[48:51]
    v_mfma_f32_16x16x32_bf16 v[48:51], v[52:55], v[112:115], v[48:51]
    s_waitcnt lgkmcnt(0)
    v_mfma_f32_16x16x32_bf16 v[20:23], v[116:119], v[148:151], v[20:23]
    ds_read_b128 v[52:55], v12 offset:0
    v_mfma_f32_16x16x32_bf16 v[24:27], v[120:123], v[148:151], v[24:27]
    ds_read_b128 v[84:87], v13 offset:3584
    v_mfma_f32_16x16x32_bf16 v[28:31], v[124:127], v[148:151], v[28:31]
    ds_read_b128 v[56:59], v12 offset:512
    v_mfma_f32_16x16x32_bf16 v[32:35], v[128:131], v[148:151], v[32:35]
    ds_read_b128 v[88:91], v13 offset:3072
    v_mfma_f32_16x16x32_bf16 v[36:39], v[132:135], v[148:151], v[36:39]
    ds_read_b128 v[60:63], v12 offset:1024
    v_mfma_f32_16x16x32_bf16 v[40:43], v[136:139], v[148:151], v[40:43]
    ds_read_b128 v[92:95], v13 offset:2560
    v_mfma_f32_16x16x32_bf16 v[44:47], v[140:143], v[148:151], v[44:47]
    ds_read_b128 v[64:67], v12 offset:1536
    v_mfma_f32_16x16x32_bf16 v[48:51], v[144:147], v[148:151], v[48:51]
    ds_read_b128 v[96:99], v13 offset:2048
    v_mfma_f32_16x16x32_bf16 v[24:27], v[116:119], v[152:155], v[24:27]
    ds_read_b128 v[68:71], v12 offset:2048
    v_mfma_f32_16x16x32_bf16 v[28:31], v[120:123], v[152:155], v[28:31]
    ds_read_b128 v[100:103], v13 offset:1536
    v_mfma_f32_16x16x32_bf16 v[32:35], v[124:127], v[152:155], v[32:35]
    ds_read_b128 v[72:75], v12 offset:2560
    v_mfma_f32_16x16x32_bf16 v[36:39], v[128:131], v[152:155], v[36:39]
    ds_read_b128 v[104:107], v13 offset:1024
    v_mfma_f32_16x16x32_bf16 v[40:43], v[132:135], v[152:155], v[40:43]
    ds_read_b128 v[76:79], v12 offset:3072
    v_mfma_f32_16x16x32_bf16 v[44:47], v[136:139], v[152:155], v[44:47]
    ds_read_b128 v[108:111], v13 offset:512
    v_mfma_f32_16x16x32_bf16 v[48:51], v[140:143], v[152:155], v[48:51]
    ds_read_b128 v[80:83], v12 offset:3584
    v_mfma_f32_16x16x32_bf16 v[28:31], v[116:119], v[156:159], v[28:31]
    ds_read_b128 v[112:115], v13 offset:0
    v_mfma_f32_16x16x32_bf16 v[32:35], v[120:123], v[156:159], v[32:35]
    v_subrev_u32 v12, 64, v12
    v_subrev_u32 v13, 64, v13
    v_mfma_f32_16x16x32_bf16 v[36:39], v[124:127], v[156:159], v[36:39]
    v_mfma_f32_16x16x32_bf16 v[40:43], v[128:131], v[156:159], v[40:43]
    v_mfma_f32_16x16x32_bf16 v[44:47], v[132:135], v[156:159], v[44:47]
    v_mfma_f32_16x16x32_bf16 v[48:51], v[136:139], v[156:159], v[48:51]
    v_mfma_f32_16x16x32_bf16 v[32:35], v[116:119], v[160:163], v[32:35]
    v_mfma_f32_16x16x32_bf16 v[36:39], v[120:123], v[160:163], v[36:39]
    v_mfma_f32_16x16x32_bf16 v[40:43], v[124:127], v[160:163], v[40:43]
    v_mfma_f32_16x16x32_bf16 v[44:47], v[128:131], v[160:163], v[44:47]
    v_mfma_f32_16x16x32_bf16 v[48:51], v[132:135], v[160:163], v[48:51]
    v_mfma_f32_16x16x32_bf16 v[36:39], v[116:119], v[164:167], v[36:39]
    v_mfma_f32_16x16x32_bf16 v[40:43], v[120:123], v[164:167], v[40:43]
    v_mfma_f32_16x16x32_bf16 v[44:47], v[124:127], v[164:167], v[44:47]
    v_mfma_f32_16x16x32_bf16 v[48:51], v[128:131], v[164:167], v[48:51]
    v_mfma_f32_16x16x32_bf16 v[40:43], v[116:119], v[168:171], v[40:43]
    v_mfma_f32_16x16x32_bf16 v[44:47], v[120:123], v[168:171], v[44:47]
    v_mfma_f32_16x16x32_bf16 v[48:51], v[124:127], v[168:171], v[48:51]
    v_mfma_f32_16x16x32_bf16 v[44:47], v[116:119], v[172:175], v[44:47]
    v_mfma_f32_16x16x32_bf16 v[48:51], v[120:123], v[172:175], v[48:51]
    v_mfma_f32_16x16x32_bf16 v[48:51], v[116:119], v[176:179], v[48:51]
    s_sub_u32 s10, s10, 1
    s_cmp_lg_u32 s10, 0
    s_cbranch_scc1 L_CV
    v_lshlrev_b32 v2, 7, v11
    v_lshl_add_u32 v2, v10, 2, v2
    v_add_u32 v3, s11, v2
    s_add_u32 s6, s9, 1312
    v_add_u32 v2, s6, v2
    v_lshlrev_b32 v4, 4, v0
    v_add_u32 v5, s6, v4
    v_lshlrev_b32 v19, 16, v19
    s_waitcnt lgkmcnt(0)
    ds_read_b32 v52, v3 offset:448
    ds_read_b32 v53, v3 offset:512
    ds_read_b32 v54, v3 offset:960
    ds_read_b32 v55, v3 offset:1024
    ds_read_b32 v56, v3 offset:1472
    ds_read_b32 v57, v3 offset:1536
    ds_read_b32 v58, v3 offset:1984
    ds_read_b32 v59, v3 offset:2048
    ds_read_b32 v60, v3 offset:2496
    ds_read_b32 v61, v3 offset:2560
    ds_read_b32 v62, v3 offset:3008
    ds_read_b32 v63, v3 offset:3072
    ds_read_b32 v64, v3 offset:3520
    ds_read_b32 v65, v3 offset:3584
    ds_read_b32 v66, v3 offset:4032
    ds_read_b32 v67, v3 offset:4096
    s_lshl_b32 s6, s8, 12
    s_add_u32 s6, s6, 13631488
    s_waitcnt lgkmcnt(12)
    v_lshlrev_b32 v68, 16, v52
    v_and_b32 v69, 0xffff0000, v52
    v_fmac_f32 v20, v68, v19
    v_fmac_f32 v21, v69, v19
    v_cvt_pk_bf16_f32 v52, v20, v21
    ds_write_b32 v2, v52 offset:0
    v_lshlrev_b32 v70, 16, v53
    v_and_b32 v71, 0xffff0000, v53
    v_fmac_f32 v22, v70, v19
    v_fmac_f32 v23, v71, v19
    v_cvt_pk_bf16_f32 v53, v22, v23
    ds_write_b32 v2, v53 offset:64
    v_lshlrev_b32 v68, 16, v54
    v_and_b32 v69, 0xffff0000, v54
    v_fmac_f32 v24, v68, v19
    v_fmac_f32 v25, v69, v19
    v_cvt_pk_bf16_f32 v54, v24, v25
    ds_write_b32 v2, v54 offset:512
    v_lshlrev_b32 v70, 16, v55
    v_and_b32 v71, 0xffff0000, v55
    v_fmac_f32 v26, v70, v19
    v_fmac_f32 v27, v71, v19
    v_cvt_pk_bf16_f32 v55, v26, v27
    ds_write_b32 v2, v55 offset:576
    s_waitcnt lgkmcnt(12)
    v_lshlrev_b32 v68, 16, v56
    v_and_b32 v69, 0xffff0000, v56
    v_fmac_f32 v28, v68, v19
    v_fmac_f32 v29, v69, v19
    v_cvt_pk_bf16_f32 v56, v28, v29
    ds_write_b32 v2, v56 offset:1024
    v_lshlrev_b32 v70, 16, v57
    v_and_b32 v71, 0xffff0000, v57
    v_fmac_f32 v30, v70, v19
    v_fmac_f32 v31, v71, v19
    v_cvt_pk_bf16_f32 v57, v30, v31
    ds_write_b32 v2, v57 offset:1088
    v_lshlrev_b32 v68, 16, v58
    v_and_b32 v69, 0xffff0000, v58
    v_fmac_f32 v32, v68, v19
    v_fmac_f32 v33, v69, v19
    v_cvt_pk_bf16_f32 v58, v32, v33
    ds_write_b32 v2, v58 offset:1536
    v_lshlrev_b32 v70, 16, v59
    v_and_b32 v71, 0xffff0000, v59
    v_fmac_f32 v34, v70, v19
    v_fmac_f32 v35, v71, v19
    v_cvt_pk_bf16_f32 v59, v34, v35
    ds_write_b32 v2, v59 offset:1600
    s_waitcnt lgkmcnt(12)
    v_lshlrev_b32 v68, 16, v60
    v_and_b32 v69, 0xffff0000, v60
    v_fmac_f32 v36, v68, v19
    v_fmac_f32 v37, v69, v19
    v_cvt_pk_bf16_f32 v60, v36, v37
    ds_write_b32 v2, v60 offset:2048
    v_lshlrev_b32 v70, 16, v61
    v_and_b32 v71, 0xffff0000, v61
    v_fmac_f32 v38, v70, v19
    v_fmac_f32 v39, v71, v19
    v_cvt_pk_bf16_f32 v61, v38, v39
    ds_write_b32 v2, v61 offset:2112
    v_lshlrev_b32 v68, 16, v62
    v_and_b32 v69, 0xffff0000, v62
    v_fmac_f32 v40, v68, v19
    v_fmac_f32 v41, v69, v19
    v_cvt_pk_bf16_f32 v62, v40, v41
    ds_write_b32 v2, v62 offset:2560
    v_lshlrev_b32 v70, 16, v63
    v_and_b32 v71, 0xffff0000, v63
    v_fmac_f32 v42, v70, v19
    v_fmac_f32 v43, v71, v19
    v_cvt_pk_bf16_f32 v63, v42, v43
    ds_write_b32 v2, v63 offset:2624
    s_waitcnt lgkmcnt(12)
    v_lshlrev_b32 v68, 16, v64
    v_and_b32 v69, 0xffff0000, v64
    v_fmac_f32 v44, v68, v19
    v_fmac_f32 v45, v69, v19
    v_cvt_pk_bf16_f32 v64, v44, v45
    ds_write_b32 v2, v64 offset:3072
    v_lshlrev_b32 v70, 16, v65
    v_and_b32 v71, 0xffff0000, v65
    v_fmac_f32 v46, v70, v19
    v_fmac_f32 v47, v71, v19
    v_cvt_pk_bf16_f32 v65, v46, v47
    ds_write_b32 v2, v65 offset:3136
    v_lshlrev_b32 v68, 16, v66
    v_and_b32 v69, 0xffff0000, v66
    v_fmac_f32 v48, v68, v19
    v_fmac_f32 v49, v69, v19
    v_cvt_pk_bf16_f32 v66, v48, v49
    ds_write_b32 v2, v66 offset:3584
    v_lshlrev_b32 v70, 16, v67
    v_and_b32 v71, 0xffff0000, v67
    v_fmac_f32 v50, v70, v19
    v_fmac_f32 v51, v71, v19
    v_cvt_pk_bf16_f32 v67, v50, v51
    ds_write_b32 v2, v67 offset:3648
    ds_read_b128 v[72:75], v5 offset:0
    ds_read_b128 v[76:79], v5 offset:1024
    ds_read_b128 v[80:83], v5 offset:2048
    ds_read_b128 v[84:87], v5 offset:3072
    s_waitcnt lgkmcnt(3)
    buffer_store_dwordx4 v[72:75], v4, s[48:51], s6 offen offset:0 sc1
    s_waitcnt lgkmcnt(2)
    buffer_store_dwordx4 v[76:79], v4, s[48:51], s6 offen offset:1024 sc1
    s_waitcnt lgkmcnt(1)
    buffer_store_dwordx4 v[80:83], v4, s[48:51], s6 offen offset:2048 sc1
    s_waitcnt lgkmcnt(0)
    buffer_store_dwordx4 v[84:87], v4, s[48:51], s6 offen offset:3072 sc1
    s_waitcnt vmcnt(0)
    s_and_b32 s6, s8, 3
    s_lshl2_add_u32 s6, s4, s6
    s_mul_i32 s6, s6, 128
    s_add_u32 s6, s6, 5120
    v_mov_b32 v2, 0
    v_mov_b32 v3, 1
    s_mov_b64 exec, 1
    buffer_atomic_add v3, v2, s[48:51], s6 offen sc1
    s_endpgm
L_S:
    buffer_load_dwordx4 v[128:131], v64, s[56:59], s10 offen nt
    buffer_load_dwordx4 v[132:135], v65, s[56:59], s10 offen nt
    buffer_load_dwordx4 v[136:139], v66, s[56:59], s10 offen nt
    buffer_load_dwordx4 v[140:143], v67, s[56:59], s10 offen nt
    buffer_load_dwordx4 v[144:147], v68, s[56:59], s10 offen nt
    buffer_load_dwordx4 v[148:151], v64, s[56:59], s11 offen nt
    buffer_load_dwordx4 v[152:155], v65, s[56:59], s11 offen nt
    buffer_load_dwordx4 v[156:159], v66, s[56:59], s11 offen nt
    buffer_load_dwordx4 v[160:163], v67, s[56:59], s11 offen nt
    buffer_load_dwordx4 v[164:167], v68, s[56:59], s11 offen nt
    v_lshrrev_b32 v1, 4, v0
    v_lshlrev_b32 v16, 2, v0
    v_add_u32 v16, 163328, v16
    v_bfe_u32 v13, v0, 2, 2
    v_mul_u32_u24 v13, 1280, v13
    v_lshl_add_u32 v13, v1, 5, v13
    v_and_b32 v2, 3, v0
    v_lshl_add_u32 v13, v2, 3, v13
    v_add_u32 v13, 152832, v13
    v_lshlrev_b32 v4, 4, v0
    v_add_u32 v6, 163584, v4
    buffer_load_dword v7, v14, s[72:75], 0 offen sc1
    ds_read_b32 v17, v16
    s_waitcnt lgkmcnt(0)
    v_cmp_gt_u32 vcc, 1, v17
    s_nop 0
    s_cbranch_vccnz SPIN_51
BACK_52:
    s_mov_b64 exec, 0xffff
    ds_read_b128 v[20:23], v6
    s_mov_b64 exec, -1
    ds_read_b64_tr_b16 v[80:81], v13 offset:0
    ds_read_b64_tr_b16 v[82:83], v13 offset:5120
    ds_read_b64_tr_b16 v[84:85], v13 offset:128
    ds_read_b64_tr_b16 v[86:87], v13 offset:5248
    ds_read_b64_tr_b16 v[88:89], v13 offset:256
    ds_read_b64_tr_b16 v[90:91], v13 offset:5376
    ds_read_b64_tr_b16 v[92:93], v13 offset:384
    ds_read_b64_tr_b16 v[94:95], v13 offset:5504
    ds_read_b64_tr_b16 v[96:97], v13 offset:512
    ds_read_b64_tr_b16 v[98:99], v13 offset:5632
    ds_read_b64_tr_b16 v[100:101], v13 offset:640
    ds_read_b64_tr_b16 v[102:103], v13 offset:5760
    ds_read_b64_tr_b16 v[104:105], v13 offset:768
    ds_read_b64_tr_b16 v[106:107], v13 offset:5888
    ds_read_b64_tr_b16 v[108:109], v13 offset:896
    ds_read_b64_tr_b16 v[110:111], v13 offset:6016
    ds_read_b64_tr_b16 v[112:113], v13 offset:1024
    ds_read_b64_tr_b16 v[114:115], v13 offset:6144
    ds_read_b64_tr_b16 v[116:117], v13 offset:1152
    ds_read_b64_tr_b16 v[118:119], v13 offset:6272
    s_lshl_b32 s6, s14, 8
    s_add_u32 s6, s6, 16384
    s_waitcnt lgkmcnt(15)
    s_mov_b64 exec, 0xffff
    buffer_store_dwordx4 v[20:23], v4, s[48:51], s6 offen sc1
    s_mov_b64 exec, -1
    v_bfe_u32 v1, v0, 2, 3
    v_lshrrev_b32 v3, 5, v0
    v_lshl_add_u32 v1, v3, 4, v1
    v_mul_u32_u24 v1, 320, v1
    v_lshl_add_u32 v1, v2, 3, v1
    v_add_u32 v1, 152832, v1
    s_lshr_b32 s6, s2, 2
    s_mul_i32 s10, s6, 5120
    s_and_b32 s7, s2, 3
    s_mul_i32 s7, s7, 552960
    s_add_u32 s10, s10, s7
    s_add_u32 s10, s10, 3145728
    s_cmp_ge_u32 s2, 216
    s_cselect_b32 s10, 536870912, s10
    s_add_u32 s15, s15, 131072
    s_waitcnt vmcnt(0)
    s_mov_b32 s12, 262144
    s_branch AG_53_c
AG_53:
    buffer_load_dword v7, v14, s[72:75], 0 offen sc1
    s_waitcnt vmcnt(0)
AG_53_c:
    v_cmp_gt_u32 vcc, 1, v7
    s_nop 0
    s_cbranch_vccz AG_53_d
    s_sleep 8
    s_sub_u32 s12, s12, 1
    s_cbranch_scc0 AG_53
AG_53_d:
    s_lshr_b32 s6, s14, 4
    s_mul_i32 s6, s6, 128
    s_add_u32 s6, s6, 9216
    v_mov_b32 v8, 1
    s_mov_b64 exec, 1
    buffer_atomic_add v8, v14, s[48:51], s6 offen sc1
    s_mov_b64 exec, -1
    s_cmp_ge_u32 s5, 4
    s_cbranch_scc1 L_S1
    v_mov_b32 v8, 1
    ds_write_b32 v15, v8
L_S1:
    s_waitcnt lgkmcnt(0)
    ds_write_b128 v69, v[128:131] offset:0
    ds_write_b128 v70, v[132:135] offset:0
    ds_write_b128 v71, v[136:139] offset:0
    ds_write_b128 v72, v[140:143] offset:0
    ds_write_b128 v73, v[144:147] offset:0
    ds_write_b128 v69, v[148:151] offset:5120
    ds_write_b128 v70, v[152:155] offset:5120
    ds_write_b128 v71, v[156:159] offset:5120
    ds_write_b128 v72, v[160:163] offset:5120
    ds_write_b128 v73, v[164:167] offset:5120
    s_waitcnt lgkmcnt(0)
    ds_read_b64_tr_b16 v[128:129], v1 offset:0
    ds_read_b64_tr_b16 v[130:131], v1 offset:2560
    ds_read_b64_tr_b16 v[132:133], v1 offset:32
    ds_read_b64_tr_b16 v[134:135], v1 offset:2592
    ds_read_b64_tr_b16 v[136:137], v1 offset:64
    ds_read_b64_tr_b16 v[138:139], v1 offset:2624
    ds_read_b64_tr_b16 v[140:141], v1 offset:96
    ds_read_b64_tr_b16 v[142:143], v1 offset:2656
    ds_read_b64_tr_b16 v[144:145], v1 offset:128
    ds_read_b64_tr_b16 v[146:147], v1 offset:2688
    ds_read_b64_tr_b16 v[148:149], v1 offset:160
    ds_read_b64_tr_b16 v[150:151], v1 offset:2720
    ds_read_b64_tr_b16 v[152:153], v1 offset:192
    ds_read_b64_tr_b16 v[154:155], v1 offset:2752
    ds_read_b64_tr_b16 v[156:157], v1 offset:224
    ds_read_b64_tr_b16 v[158:159], v1 offset:2784
    ds_read_b64_tr_b16 v[160:161], v1 offset:256
    ds_read_b64_tr_b16 v[162:163], v1 offset:2816
    ds_read_b64_tr_b16 v[164:165], v1 offset:288
    ds_read_b64_tr_b16 v[166:167], v1 offset:2848
    v_add_u32 v18, -256, v16
    buffer_store_dwordx4 v[80:83], v4, s[48:51], s15 offen offset:0 sc1
    buffer_store_dwordx4 v[84:87], v4, s[48:51], s15 offen offset:1024 sc1
    buffer_store_dwordx4 v[88:91], v4, s[48:51], s15 offen offset:2048 sc1
    buffer_store_dwordx4 v[92:95], v4, s[48:51], s15 offen offset:3072 sc1
    s_add_u32 s15, s15, 4096
    buffer_store_dwordx4 v[96:99], v4, s[48:51], s15 offen offset:0 sc1
    ds_read_b32 v17, v18
    s_waitcnt lgkmcnt(0)
    v_cmp_gt_u32 vcc, 2, v17
    s_nop 0
    s_cbranch_vccnz SPIN_54
BACK_55:
    buffer_store_dwordx4 v[100:103], v4, s[48:51], s15 offen offset:1024 sc1
    buffer_store_dwordx4 v[104:107], v4, s[48:51], s15 offen offset:2048 sc1
    buffer_store_dwordx4 v[108:111], v4, s[48:51], s15 offen offset:3072 sc1
    s_add_u32 s15, s15, 4096
    buffer_store_dwordx4 v[112:115], v4, s[48:51], s15 offen offset:0 sc1
    buffer_store_dwordx4 v[116:119], v4, s[48:51], s15 offen offset:1024 sc1
    s_waitcnt lgkmcnt(0)
    s_add_u32 s6, s10, 0
    s_add_u32 s7, s6, 4096
    ds_read_b32 v17, v18
    s_waitcnt lgkmcnt(0)
    v_cmp_gt_u32 vcc, 3, v17
    s_nop 0
    s_cbranch_vccnz SPIN_56
BACK_57:
    buffer_store_dwordx4 v[128:131], v4, s[48:51], s6 offen offset:0 sc1
    buffer_store_dwordx4 v[132:135], v4, s[48:51], s6 offen offset:1024 sc1
    buffer_store_dwordx4 v[136:139], v4, s[48:51], s6 offen offset:2048 sc1
    buffer_store_dwordx4 v[140:143], v4, s[48:51], s6 offen offset:3072 sc1
    buffer_store_dwordx4 v[144:147], v4, s[48:51], s7 offen sc1
    s_add_u32 s6, s10, 276480
    s_add_u32 s7, s6, 4096
    ds_read_b32 v17, v18
    s_waitcnt lgkmcnt(0)
    v_cmp_gt_u32 vcc, 4, v17
    s_nop 0
    s_cbranch_vccnz SPIN_58
BACK_59:
    buffer_store_dwordx4 v[148:151], v4, s[48:51], s6 offen offset:0 sc1
    buffer_store_dwordx4 v[152:155], v4, s[48:51], s6 offen offset:1024 sc1
    buffer_store_dwordx4 v[156:159], v4, s[48:51], s6 offen offset:2048 sc1
    buffer_store_dwordx4 v[160:163], v4, s[48:51], s6 offen offset:3072 sc1
    buffer_store_dwordx4 v[164:167], v4, s[48:51], s7 offen sc1
    v_add_u32 v18, -256, v16
    v_and_b32 v5, 7, v0
    v_mul_u32_u24 v5, 128, v5
    v_add_u32 v5, 0, v5
    s_waitcnt vmcnt(0)
    s_mul_i32 s6, s4, 128
    s_add_u32 s6, s6, 0
    v_mov_b32 v8, 1
    s_mov_b64 exec, 1
    buffer_atomic_add v8, v14, s[48:51], s6 offen sc1
    s_mov_b64 exec, -1
    s_cmp_lt_u32 s5, 4
    s_cbranch_scc1 L_S2
    s_sub_u32 s6, s5, 4
    s_mul_i32 s7, s6, 37
    s_lshr_b32 s7, s7, 8
    s_mul_i32 s0, s7, 7
    s_sub_u32 s0, s6, s0
    s_lshr_b32 s6, s4, 1
    s_lshl2_add_u32 s6, s6, s7
    s_mul_i32 s6, s6, 128
    s_add_u32 s6, s6, 9216
    s_add_u32 s40, s44, s6
    s_addc_u32 s41, s45, 0
    s_and_b32 s6, s4, 1
    s_mul_i32 s6, s6, 7
    s_add_u32 s6, s6, s0
    s_mul_i32 s6, s6, 128
    s_add_u32 s6, s6, 11264
    s_add_u32 s38, s44, s6
    s_addc_u32 s39, s45, 0
    ds_read_b32 v17, v18
    s_waitcnt lgkmcnt(0)
    v_cmp_gt_u32 vcc, 7, v17
    s_nop 0
    s_cbranch_vccnz SPIN_60
BACK_61:
    s_mov_b32 s12, 262144
AG_62:
    s_load_dword s16, s[40:41], 0 glc
    s_waitcnt lgkmcnt(0)
    s_cmp_ge_u32 s16, 16
    s_cbranch_scc1 AG_62_d
    s_sleep 4
    s_sub_u32 s12, s12, 1
    s_cbranch_scc0 AG_62
AG_62_d:
    s_mov_b32 s12, 262144
AG_63:
    s_load_dword s16, s[38:39], 0 glc
    s_waitcnt lgkmcnt(0)
    s_cmp_ge_u32 s16, 2
    s_cbranch_scc1 AG_63_d
    s_sleep 4
    s_sub_u32 s12, s12, 1
    s_cbranch_scc0 AG_63
AG_63_d:
    v_mov_b32 v8, 1
    ds_write_b32 v15, v8
    ds_read_b32 v17, v18
    s_waitcnt lgkmcnt(0)
    v_cmp_gt_u32 vcc, 9, v17
    s_nop 0
    s_cbranch_vccnz SPIN_64
BACK_65:
    s_branch L_S3
L_S2:
    v_mov_b32 v16, 163328
    ds_read_b32 v17, v16
    s_waitcnt lgkmcnt(0)
    v_cmp_gt_u32 vcc, 2, v17
    s_nop 0
    s_cbranch_vccnz SPIN_66
BACK_67:
L_S3:
    s_and_b32 s6, s5, 7
    s_lshr_b32 s13, s4, 1
    s_lshl3_add_u32 s13, s13, s6
    s_lshr_b32 s7, s5, 3
    s_and_b32 s14, s4, 1
    s_lshl2_add_u32 s14, s14, s7
    s_mul_i32 s15, s7, 7
    s_lshr_b32 s15, s15, 1
    s_mul_i32 s10, s14, 276480
    s_add_u32 s10, s10, 3145728
    s_mul_i32 s6, s14, 160
    s_mov_b64 exec, 0x3ff
    buffer_load_dwordx4 v[20:23], v4, s[60:63], s6 offen
    s_mov_b64 exec, -1
    s_mov_b32 s12, 262144
AG_68:
    buffer_load_dword v7, v5, s[48:51], 0 offen sc1
    s_waitcnt vmcnt(0)
AG_68_c:
    v_cmp_gt_u32 vcc, 32, v7
    s_nop 0
    s_cbranch_vccz AG_68_d
    s_sleep 4
    s_sub_u32 s12, s12, 1
    s_cbranch_scc0 AG_68
AG_68_d:
    s_mov_b64 exec, 0x3ff
    ds_write_b128 v6, v[20:23]
    s_mov_b64 exec, -1
    v_mov_b32 v8, 2
    ds_write_b32 v15, v8
    ds_read_b32 v17, v18
    s_waitcnt lgkmcnt(0)
    v_cmp_gt_u32 vcc, 10, v17
    s_nop 0
    s_cbranch_vccnz SPIN_69
BACK_70:
    s_mul_i32 s7, s5, 3
    s_lshl1_add_u32 s8, s5, 16
    s_cmp_lt_u32 s5, 16
    s_cselect_b32 s8, s7, s8
    s_mul_i32 s6, s4, 80
    s_add_u32 s8, s8, s6
    v_lshrrev_b32 v2, 2, v0
    v_and_b32 v6, 3, v0
    v_mul_u32_u24 v3, 10240, v2
    v_lshl_add_u32 v3, v6, 4, v3
    s_lshl_b32 s6, s8, 4
    s_add_u32 s6, s6, 131072
    buffer_load_dwordx4 v[128:131], v3, s[48:51], s6 offen sc1
    s_add_u32 s6, s6, 163840
    buffer_load_dwordx4 v[132:135], v3, s[48:51], s6 offen sc1
    s_add_u32 s6, s6, 163840
    buffer_load_dwordx4 v[136:139], v3, s[48:51], s6 offen sc1
    s_add_u32 s6, s6, 163840
    buffer_load_dwordx4 v[140:143], v3, s[48:51], s6 offen sc1
    s_add_u32 s6, s6, 163840
    buffer_load_dwordx4 v[144:147], v3, s[48:51], s6 offen sc1
    s_add_u32 s6, s6, 163840
    buffer_load_dwordx4 v[148:151], v3, s[48:51], s6 offen sc1
    s_add_u32 s6, s6, 163840
    buffer_load_dwordx4 v[152:155], v3, s[48:51], s6 offen sc1
    s_add_u32 s6, s6, 163840
    buffer_load_dwordx4 v[156:159], v3, s[48:51], s6 offen sc1
    s_add_u32 s6, s6, 163840
    buffer_load_dwordx4 v[160:163], v3, s[48:51], s6 offen sc1
    s_add_u32 s6, s6, 163840
    buffer_load_dwordx4 v[164:167], v3, s[48:51], s6 offen sc1
    s_add_u32 s6, s6, 163840
    buffer_load_dwordx4 v[168:171], v3, s[48:51], s6 offen sc1
    s_add_u32 s6, s6, 163840
    buffer_load_dwordx4 v[172:175], v3, s[48:51], s6 offen sc1
    s_add_u32 s6, s6, 163840
    buffer_load_dwordx4 v[176:179], v3, s[48:51], s6 offen sc1
    s_add_u32 s6, s6, 163840
    buffer_load_dwordx4 v[180:183], v3, s[48:51], s6 offen sc1
    s_add_u32 s6, s6, 163840
    buffer_load_dwordx4 v[184:187], v3, s[48:51], s6 offen sc1
    s_add_u32 s6, s6, 163840
    buffer_load_dwordx4 v[188:191], v3, s[48:51], s6 offen sc1
    v_mul_u32_u24 v6, 9152, v6
    v_lshl_add_u32 v2, v2, 4, v6
    v_add_u32 v2, 61440, v2
    v_mov_b32 v20, 0
    v_mov_b32 v21, 0
    v_mov_b32 v22, 0
    v_mov_b32 v23, 0
    v_add_u32 v3, 61440, v4
    ds_read_b32 v17, v18
    s_waitcnt lgkmcnt(0)
    v_cmp_gt_u32 vcc, 11, v17
    s_nop 0
    s_cbranch_vccnz SPIN_71
BACK_72:
    s_mov_b64 exec, 0xfffffff
    ds_write_b128 v3, v[20:23] offset:0
    ds_write_b128 v3, v[20:23] offset:4576
    ds_write_b128 v3, v[20:23] offset:9152
    ds_write_b128 v3, v[20:23] offset:13728
    ds_write_b128 v3, v[20:23] offset:18304
    ds_write_b128 v3, v[20:23] offset:22880
    s_mov_b32 exec_lo, 0x77777777
    s_mov_b32 exec_hi, 0x77777777
    s_waitcnt vmcnt(15)
    ds_write_b128 v2, v[128:131] offset:448
    s_waitcnt vmcnt(14)
    ds_write_b128 v2, v[132:135] offset:704
    s_waitcnt vmcnt(13)
    ds_write_b128 v2, v[136:139] offset:960
    s_waitcnt vmcnt(12)
    ds_write_b128 v2, v[140:143] offset:1216
    s_waitcnt vmcnt(11)
    ds_write_b128 v2, v[144:147] offset:1472
    s_waitcnt vmcnt(10)
    ds_write_b128 v2, v[148:151] offset:1728
    s_waitcnt vmcnt(9)
    ds_write_b128 v2, v[152:155] offset:1984
    s_waitcnt vmcnt(8)
    ds_write_b128 v2, v[156:159] offset:2240
    s_waitcnt vmcnt(7)
    ds_write_b128 v2, v[160:163] offset:2496
    s_waitcnt vmcnt(6)
    ds_write_b128 v2, v[164:167] offset:2752
    s_waitcnt vmcnt(5)
    ds_write_b128 v2, v[168:171] offset:3008
    s_waitcnt vmcnt(4)
    ds_write_b128 v2, v[172:175] offset:3264
    s_waitcnt vmcnt(3)
    ds_write_b128 v2, v[176:179] offset:3520
    s_waitcnt vmcnt(2)
    ds_write_b128 v2, v[180:183] offset:3776
    s_waitcnt vmcnt(1)
    ds_write_b128 v2, v[184:187] offset:4032
    s_waitcnt vmcnt(0)
    ds_write_b128 v2, v[188:191] offset:4288
    s_mov_b64 exec, -1
    v_mov_b32 v8, 3
    ds_write_b32 v9, v8
    v_add_u32 v5, 4096, v4
    s_add_u32 s6, s15, 5
    s_cmp_ge_u32 s6, 14
    s_cselect_b32 s7, 14, 0
    s_sub_u32 s6, s6, s7
    s_lshl_b32 s6, s6, 2
    s_add_u32 s7, s6, 0
    s_mul_i32 s0, s7, 5120
    s_add_u32 s0, s0, s10
    s_mov_b32 m0, 0
    s_nop 0
    buffer_load_dwordx4 v4, s[48:51], s0 offen offset:0 sc1 lds
    buffer_load_dwordx4 v4, s[48:51], s0 offen offset:1024 sc1 lds
    buffer_load_dwordx4 v4, s[48:51], s0 offen offset:2048 sc1 lds
    buffer_load_dwordx4 v4, s[48:51], s0 offen offset:3072 sc1 lds
    s_mov_b32 m0, 4096
    s_nop 0
    buffer_load_dwordx4 v5, s[48:51], s0 offen sc1 lds
    s_waitcnt vmcnt(30)
    s_add_u32 s7, s6, 1
    s_mul_i32 s0, s7, 5120
    s_add_u32 s0, s0, s10
    s_mov_b32 m0, 15360
    s_nop 0
    buffer_load_dwordx4 v4, s[48:51], s0 offen offset:0 sc1 lds
    buffer_load_dwordx4 v4, s[48:51], s0 offen offset:1024 sc1 lds
    buffer_load_dwordx4 v4, s[48:51], s0 offen offset:2048 sc1 lds
    buffer_load_dwordx4 v4, s[48:51], s0 offen offset:3072 sc1 lds
    s_mov_b32 m0, 19456
    s_nop 0
    buffer_load_dwordx4 v5, s[48:51], s0 offen sc1 lds
    s_waitcnt vmcnt(30)
    s_add_u32 s6, s15, 5
    s_cmp_ge_u32 s6, 13
    s_cselect_b32 s7, 13, 0
    s_sub_u32 s6, s6, s7
    s_lshl_b32 s6, s6, 2
    s_add_u32 s7, s6, 2
    s_mul_i32 s0, s7, 5120
    s_add_u32 s0, s0, s10
    s_mov_b32 m0, 30720
    s_nop 0
    buffer_load_dwordx4 v4, s[48:51], s0 offen offset:0 sc1 lds
    buffer_load_dwordx4 v4, s[48:51], s0 offen offset:1024 sc1 lds
    buffer_load_dwordx4 v4, s[48:51], s0 offen offset:2048 sc1 lds
    buffer_load_dwordx4 v4, s[48:51], s0 offen offset:3072 sc1 lds
    s_mov_b32 m0, 34816
    s_nop 0
    buffer_load_dwordx4 v5, s[48:51], s0 offen sc1 lds
    s_waitcnt vmcnt(30)
    s_add_u32 s7, s6, 3
    s_mul_i32 s0, s7, 5120
    s_add_u32 s0, s0, s10
    s_mov_b32 m0, 46080
    s_nop 0
    buffer_load_dwordx4 v4, s[48:51], s0 offen offset:0 sc1 lds
    buffer_load_dwordx4 v4, s[48:51], s0 offen offset:1024 sc1 lds
    buffer_load_dwordx4 v4, s[48:51], s0 offen offset:2048 sc1 lds
    buffer_load_dwordx4 v4, s[48:51], s0 offen offset:3072 sc1 lds
    s_mov_b32 m0, 50176
    s_nop 0
    buffer_load_dwordx4 v5, s[48:51], s0 offen sc1 lds
    s_waitcnt vmcnt(30)
    s_add_u32 s6, s15, 6
    s_cmp_ge_u32 s6, 14
    s_cselect_b32 s7, 14, 0
    s_sub_u32 s6, s6, s7
    s_lshl_b32 s6, s6, 2
    s_add_u32 s7, s6, 0
    s_mul_i32 s0, s7, 5120
    s_add_u32 s0, s0, s10
    s_mov_b32 m0, 5120
    s_nop 0
    buffer_load_dwordx4 v4, s[48:51], s0 offen offset:0 sc1 lds
    buffer_load_dwordx4 v4, s[48:51], s0 offen offset:1024 sc1 lds
    buffer_load_dwordx4 v4, s[48:51], s0 offen offset:2048 sc1 lds
    buffer_load_dwordx4 v4, s[48:51], s0 offen offset:3072 sc1 lds
    s_mov_b32 m0, 9216
    s_nop 0
    buffer_load_dwordx4 v5, s[48:51], s0 offen sc1 lds
    s_waitcnt vmcnt(30)
    s_add_u32 s7, s6, 1
    s_mul_i32 s0, s7, 5120
    s_add_u32 s0, s0, s10
    s_mov_b32 m0, 20480
    s_nop 0
    buffer_load_dwordx4 v4, s[48:51], s0 offen offset:0 sc1 lds
    buffer_load_dwordx4 v4, s[48:51], s0 offen offset:1024 sc1 lds
    buffer_load_dwordx4 v4, s[48:51], s0 offen offset:2048 sc1 lds
    buffer_load_dwordx4 v4, s[48:51], s0 offen offset:3072 sc1 lds
    s_mov_b32 m0, 24576
    s_nop 0
    buffer_load_dwordx4 v5, s[48:51], s0 offen sc1 lds
    s_waitcnt vmcnt(30)
    s_add_u32 s6, s15, 6
    s_cmp_ge_u32 s6, 13
    s_cselect_b32 s7, 13, 0
    s_sub_u32 s6, s6, s7
    s_lshl_b32 s6, s6, 2
    s_add_u32 s7, s6, 2
    s_mul_i32 s0, s7, 5120
    s_add_u32 s0, s0, s10
    s_mov_b32 m0, 35840
    s_nop 0
    buffer_load_dwordx4 v4, s[48:51], s0 offen offset:0 sc1 lds
    buffer_load_dwordx4 v4, s[48:51], s0 offen offset:1024 sc1 lds
    buffer_load_dwordx4 v4, s[48:51], s0 offen offset:2048 sc1 lds
    buffer_load_dwordx4 v4, s[48:51], s0 offen offset:3072 sc1 lds
    s_mov_b32 m0, 39936
    s_nop 0
    buffer_load_dwordx4 v5, s[48:51], s0 offen sc1 lds
    s_waitcnt vmcnt(30)
    s_add_u32 s7, s6, 3
    s_mul_i32 s0, s7, 5120
    s_add_u32 s0, s0, s10
    s_mov_b32 m0, 51200
    s_nop 0
    buffer_load_dwordx4 v4, s[48:51], s0 offen offset:0 sc1 lds
    buffer_load_dwordx4 v4, s[48:51], s0 offen offset:1024 sc1 lds
    buffer_load_dwordx4 v4, s[48:51], s0 offen offset:2048 sc1 lds
    buffer_load_dwordx4 v4, s[48:51], s0 offen offset:3072 sc1 lds
    s_mov_b32 m0, 55296
    s_nop 0
    buffer_load_dwordx4 v5, s[48:51], s0 offen sc1 lds
    s_waitcnt vmcnt(30)
    s_add_u32 s6, s15, 7
    s_cmp_ge_u32 s6, 14
    s_cselect_b32 s7, 14, 0
    s_sub_u32 s6, s6, s7
    s_lshl_b32 s6, s6, 2
    s_add_u32 s7, s6, 0
    s_mul_i32 s0, s7, 5120
    s_add_u32 s0, s0, s10
    s_mov_b32 m0, 10240
    s_nop 0
    buffer_load_dwordx4 v4, s[48:51], s0 offen offset:0 sc1 lds
    buffer_load_dwordx4 v4, s[48:51], s0 offen offset:1024 sc1 lds
    buffer_load_dwordx4 v4, s[48:51], s0 offen offset:2048 sc1 lds
    buffer_load_dwordx4 v4, s[48:51], s0 offen offset:3072 sc1 lds
    s_mov_b32 m0, 14336
    s_nop 0
    buffer_load_dwordx4 v5, s[48:51], s0 offen sc1 lds
    s_waitcnt vmcnt(30)
    s_add_u32 s7, s6, 1
    s_mul_i32 s0, s7, 5120
    s_add_u32 s0, s0, s10
    s_mov_b32 m0, 25600
    s_nop 0
    buffer_load_dwordx4 v4, s[48:51], s0 offen offset:0 sc1 lds
    buffer_load_dwordx4 v4, s[48:51], s0 offen offset:1024 sc1 lds
    buffer_load_dwordx4 v4, s[48:51], s0 offen offset:2048 sc1 lds
    buffer_load_dwordx4 v4, s[48:51], s0 offen offset:3072 sc1 lds
    s_mov_b32 m0, 29696
    s_nop 0
    buffer_load_dwordx4 v5, s[48:51], s0 offen sc1 lds
    s_waitcnt vmcnt(30)
    s_add_u32 s6, s15, 7
    s_cmp_ge_u32 s6, 13
    s_cselect_b32 s7, 13, 0
    s_sub_u32 s6, s6, s7
    s_lshl_b32 s6, s6, 2
    s_add_u32 s7, s6, 2
    s_mul_i32 s0, s7, 5120
    s_add_u32 s0, s0, s10
    s_mov_b32 m0, 40960
    s_nop 0
    buffer_load_dwordx4 v4, s[48:51], s0 offen offset:0 sc1 lds
    buffer_load_dwordx4 v4, s[48:51], s0 offen offset:1024 sc1 lds
    buffer_load_dwordx4 v4, s[48:51], s0 offen offset:2048 sc1 lds
    buffer_load_dwordx4 v4, s[48:51], s0 offen offset:3072 sc1 lds
    s_mov_b32 m0, 45056
    s_nop 0
    buffer_load_dwordx4 v5, s[48:51], s0 offen sc1 lds
    s_waitcnt vmcnt(30)
    s_add_u32 s7, s6, 3
    s_mul_i32 s0, s7, 5120
    s_add_u32 s0, s0, s10
    s_mov_b32 m0, 56320
    s_nop 0
    buffer_load_dwordx4 v4, s[48:51], s0 offen offset:0 sc1 lds
    buffer_load_dwordx4 v4, s[48:51], s0 offen offset:1024 sc1 lds
    buffer_load_dwordx4 v4, s[48:51], s0 offen offset:2048 sc1 lds
    buffer_load_dwordx4 v4, s[48:51], s0 offen offset:3072 sc1 lds
    s_mov_b32 m0, 60416
    s_nop 0
    buffer_load_dwordx4 v5, s[48:51], s0 offen sc1 lds
    s_waitcnt vmcnt(30)
    s_mul_i32 s6, s13, 128
    s_add_u32 s6, s6, 1024
    s_add_u32 s40, s44, s6
    s_addc_u32 s41, s45, 0
    s_waitcnt vmcnt(0)
    ds_read_b32 v17, v18
    s_waitcnt lgkmcnt(0)
    v_cmp_gt_u32 vcc, 12, v17
    s_nop 0
    s_cbranch_vccnz SPIN_73
BACK_74:
    s_mov_b32 s12, 262144
AG_75:
    s_load_dword s16, s[40:41], 0 glc
    s_waitcnt lgkmcnt(0)
    s_cmp_ge_u32 s16, 28
    s_cbranch_scc1 AG_75_d
    s_sleep 2
    s_sub_u32 s12, s12, 1
    s_cbranch_scc0 AG_75
AG_75_d:
    v_mov_b32 v8, 4
    ds_write_b32 v15, v8
    ds_read_b32 v17, v18
    s_waitcnt lgkmcnt(0)
    v_cmp_gt_u32 vcc, 13, v17
    s_nop 0
    s_cbranch_vccnz SPIN_76
BACK_77:
    s_mul_i32 s6, s14, 512
    s_add_u32 s6, s6, 5120
    s_add_u32 s40, s44, s6
    s_addc_u32 s41, s45, 0
    s_mov_b32 s12, 262144
AG_78:
    s_load_dword s16, s[40:41], 0 glc
    s_load_dword s17, s[40:41], 128 glc
    s_load_dword s18, s[40:41], 256 glc
    s_load_dword s19, s[40:41], 384 glc
    s_waitcnt lgkmcnt(0)
    s_min_u32 s16, s16, s17
    s_min_u32 s16, s16, s18
    s_min_u32 s16, s16, s19
    s_cmp_ge_u32 s16, 20
    s_cbranch_scc1 AG_78_d
    s_sleep 4
    s_sub_u32 s12, s12, 1
    s_cbranch_scc0 AG_78
AG_78_d:
    v_mov_b32 v8, 5
    ds_write_b32 v15, v8
L_END:
    s_endpgm
SPIN_3:
    s_mov_b32 s12, 2097152
SPIN_3_a:
    ds_read_b32 v250, v10
    s_waitcnt lgkmcnt(0)
    v_cmp_gt_u32 vcc, v11, v250
    s_nop 0
    s_cbranch_vccz BACK_4
    s_sub_u32 s12, s12, 1
    s_cbranch_scc0 SPIN_3_a
    s_branch BACK_4
SPIN_5:
    s_mov_b32 s12, 2097152
SPIN_5_a:
    ds_read_b32 v250, v10
    s_waitcnt lgkmcnt(0)
    v_cmp_gt_u32 vcc, v11, v250
    s_nop 0
    s_cbranch_vccz BACK_6
    s_sub_u32 s12, s12, 1
    s_cbranch_scc0 SPIN_5_a
    s_branch BACK_6
SPIN_7:
    s_mov_b32 s12, 2097152
SPIN_7_a:
    ds_read_b32 v250, v10
    s_waitcnt lgkmcnt(0)
    v_cmp_gt_u32 vcc, v11, v250
    s_nop 0
    s_cbranch_vccz BACK_8
    s_sub_u32 s12, s12, 1
    s_cbranch_scc0 SPIN_7_a
    s_branch BACK_8
SPIN_9:
    s_mov_b32 s12, 2097152
SPIN_9_a:
    ds_read_b32 v250, v10
    s_waitcnt lgkmcnt(0)
    v_cmp_gt_u32 vcc, v11, v250
    s_nop 0
    s_cbranch_vccz BACK_10
    s_sub_u32 s12, s12, 1
    s_cbranch_scc0 SPIN_9_a
    s_branch BACK_10
SPIN_11:
    s_mov_b32 s12, 2097152
SPIN_11_a:
    ds_read_b32 v250, v10
    s_waitcnt lgkmcnt(0)
    v_cmp_gt_u32 vcc, v11, v250
    s_nop 0
    s_cbranch_vccz BACK_12
    s_sub_u32 s12, s12, 1
    s_cbranch_scc0 SPIN_11_a
    s_branch BACK_12
SPIN_13:
    s_mov_b32 s12, 2097152
SPIN_13_a:
    ds_read_b32 v250, v10
    s_waitcnt lgkmcnt(0)
    v_cmp_gt_u32 vcc, v11, v250
    s_nop 0
    s_cbranch_vccz BACK_14
    s_sub_u32 s12, s12, 1
    s_cbranch_scc0 SPIN_13_a
    s_branch BACK_14
SPIN_15:
    s_mov_b32 s12, 2097152
SPIN_15_a:
    ds_read_b32 v250, v10
    s_waitcnt lgkmcnt(0)
    v_cmp_gt_u32 vcc, v11, v250
    s_nop 0
    s_cbranch_vccz BACK_16
    s_sub_u32 s12, s12, 1
    s_cbranch_scc0 SPIN_15_a
    s_branch BACK_16
SPIN_17:
    s_mov_b32 s12, 2097152
SPIN_17_a:
    ds_read_b32 v250, v10
    s_waitcnt lgkmcnt(0)
    v_cmp_gt_u32 vcc, v11, v250
    s_nop 0
    s_cbranch_vccz BACK_18
    s_sub_u32 s12, s12, 1
    s_cbranch_scc0 SPIN_17_a
    s_branch BACK_18
SPIN_19:
    s_mov_b32 s12, 2097152
SPIN_19_a:
    ds_read_b32 v250, v10
    s_waitcnt lgkmcnt(0)
    v_cmp_gt_u32 vcc, v11, v250
    s_nop 0
    s_cbranch_vccz BACK_20
    s_sub_u32 s12, s12, 1
    s_cbranch_scc0 SPIN_19_a
    s_branch BACK_20
SPIN_21:
    s_mov_b32 s12, 2097152
SPIN_21_a:
    ds_read_b32 v251, v252
    s_waitcnt lgkmcnt(0)
    v_cmp_gt_u32 vcc, 1, v251
    s_nop 0
    s_cbranch_vccz BACK_22
    s_sub_u32 s12, s12, 1
    s_cbranch_scc0 SPIN_21_a
    s_branch BACK_22
SPIN_23:
    s_mov_b32 s12, 2097152
SPIN_23_a:
    ds_read_b32 v250, v10
    s_waitcnt lgkmcnt(0)
    v_cmp_gt_u32 vcc, v11, v250
    s_nop 0
    s_cbranch_vccz BACK_24
    s_sub_u32 s12, s12, 1
    s_cbranch_scc0 SPIN_23_a
    s_branch BACK_24
SPIN_25:
    s_mov_b32 s12, 2097152
SPIN_25_a:
    ds_read_b32 v7, v2
    s_waitcnt lgkmcnt(0)
    v_cmp_gt_u32 vcc, 2, v7
    s_nop 0
    s_cbranch_vccz BACK_26
    s_sub_u32 s12, s12, 1
    s_cbranch_scc0 SPIN_25_a
    s_branch BACK_26
SPIN_27:
    s_mov_b32 s12, 2097152
SPIN_27_a:
    ds_read_b32 v7, v2
    s_waitcnt lgkmcnt(0)
    v_cmp_gt_u32 vcc, 4, v7
    s_nop 0
    s_cbranch_vccz BACK_28
    s_sub_u32 s12, s12, 1
    s_cbranch_scc0 SPIN_27_a
    s_branch BACK_28
SPIN_29:
    s_mov_b32 s12, 2097152
SPIN_29_a:
    ds_read_b32 v26, v10
    s_waitcnt lgkmcnt(0)
    v_cmp_gt_u32 vcc, v11, v26
    s_nop 0
    s_cbranch_vccz BACK_30
    s_sub_u32 s12, s12, 1
    s_cbranch_scc0 SPIN_29_a
    s_branch BACK_30
L_SKIP13:
    ds_write_b128 v99, v[132:135] offset:0
    ds_write_b128 v99, v[136:139] offset:1024
    ds_write_b128 v99, v[140:143] offset:2048
    ds_write_b128 v99, v[144:147] offset:3072
    ds_write_b128 v99, v[148:151] offset:4096
    ds_write_b128 v100, v[152:155] offset:0
    ds_write_b128 v100, v[156:159] offset:1024
    ds_write_b128 v100, v[160:163] offset:2048
    ds_write_b128 v100, v[164:167] offset:3072
    ds_write_b128 v100, v[168:171] offset:4096
    ds_write_b128 v101, v[172:175] offset:0
    s_branch L_BACK13
SPIN_31:
    s_mov_b32 s12, 2097152
SPIN_31_a:
    ds_read_b32 v8, v2
    s_waitcnt lgkmcnt(0)
    v_cmp_gt_u32 vcc, 5, v8
    s_nop 0
    s_cbranch_vccz SPIN_31_d
    s_sub_u32 s12, s12, 1
    s_cbranch_scc0 SPIN_31_a
SPIN_31_d:
    buffer_load_dwordx4 v[12:15], v98, s[48:51], s44 offen sc1
    s_add_u32 s6, s44, 131072
    buffer_load_dwordx4 v[16:19], v98, s[48:51], s6 offen sc1
    s_add_u32 s6, s44, 262144
    s_mov_b32 exec_hi, 0
    buffer_load_dwordx4 v[20:23], v98, s[48:51], s6 offen sc1
    s_mov_b64 exec, -1
    s_branch BACK_32
SPIN_33:
    s_mov_b32 s12, 2097152
SPIN_33_a:
    ds_read_b32 v26, v10
    s_waitcnt lgkmcnt(0)
    v_cmp_gt_u32 vcc, v11, v26
    s_nop 0
    s_cbranch_vccz BACK_34
    s_sub_u32 s12, s12, 1
    s_cbranch_scc0 SPIN_33_a
    s_branch BACK_34
SPIN_37:
    s_mov_b32 s12, 2097152
SPIN_37_a:
    ds_read_b32 v8, v10
    s_waitcnt lgkmcnt(0)
    v_cmp_gt_u32 vcc, 1, v8
    s_nop 0
    s_cbranch_vccz BACK_38
    s_sub_u32 s12, s12, 1
    s_cbranch_scc0 SPIN_37_a
    s_branch BACK_38
SPIN_39:
    s_mov_b32 s12, 2097152
SPIN_39_a:
    s_sleep 1
    ds_read_b32 v8, v2
    s_waitcnt lgkmcnt(0)
    v_cmp_gt_u32 vcc, 1, v8
    s_nop 0
    s_cbranch_vccz BACK_40
    s_sub_u32 s12, s12, 1
    s_cbranch_scc0 SPIN_39_a
    s_branch BACK_40
SPIN_41:
    s_mov_b32 s12, 2097152
SPIN_41_a:
    s_sleep 1
    ds_read_b32 v12, v254
    s_waitcnt lgkmcnt(0)
    v_cmp_gt_u32 vcc, 2, v12
    s_nop 0
    s_cbranch_vccz BACK_42
    s_sub_u32 s12, s12, 1
    s_cbranch_scc0 SPIN_41_a
    s_branch BACK_42
SPIN_45:
    s_mov_b32 s12, 2097152
SPIN_45_a:
    s_sleep 1
    ds_read_b32 v17, v15
    s_waitcnt lgkmcnt(0)
    v_cmp_gt_u32 vcc, 1, v17
    s_nop 0
    s_cbranch_vccz BACK_46
    s_sub_u32 s12, s12, 1
    s_cbranch_scc0 SPIN_45_a
    s_branch BACK_46
SPIN_47:
    s_mov_b32 s12, 2097152
SPIN_47_a:
    s_sleep 1
    ds_read_b32 v17, v18
    s_waitcnt lgkmcnt(0)
    v_cmp_gt_u32 vcc, 3, v17
    s_nop 0
    s_cbranch_vccz BACK_48
    s_sub_u32 s12, s12, 1
    s_cbranch_scc0 SPIN_47_a
    s_branch BACK_48
SPIN_49:
    s_mov_b32 s12, 2097152
SPIN_49_a:
    s_sleep 1
    ds_read_b32 v17, v15
    s_waitcnt lgkmcnt(0)
    v_cmp_gt_u32 vcc, 12, v17
    s_nop 0
    s_cbranch_vccz BACK_50
    s_sub_u32 s12, s12, 1
    s_cbranch_scc0 SPIN_49_a
    s_branch BACK_50
SPIN_51:
    s_mov_b32 s12, 2097152
SPIN_51_a:
    ds_read_b32 v17, v16
    s_waitcnt lgkmcnt(0)
    v_cmp_gt_u32 vcc, 1, v17
    s_nop 0
    s_cbranch_vccz BACK_52
    s_sub_u32 s12, s12, 1
    s_cbranch_scc0 SPIN_51_a
    s_branch BACK_52
SPIN_54:
    s_mov_b32 s12, 2097152
SPIN_54_a:
    s_sleep 1
    ds_read_b32 v17, v18
    s_waitcnt lgkmcnt(0)
    v_cmp_gt_u32 vcc, 2, v17
    s_nop 0
    s_cbranch_vccz BACK_55
    s_sub_u32 s12, s12, 1
    s_cbranch_scc0 SPIN_54_a
    s_branch BACK_55
SPIN_56:
    s_mov_b32 s12, 2097152
SPIN_56_a:
    s_sleep 1
    ds_read_b32 v17, v18
    s_waitcnt lgkmcnt(0)
    v_cmp_gt_u32 vcc, 3, v17
    s_nop 0
    s_cbranch_vccz BACK_57
    s_sub_u32 s12, s12, 1
    s_cbranch_scc0 SPIN_56_a
    s_branch BACK_57
SPIN_58:
    s_mov_b32 s12, 2097152
SPIN_58_a:
    s_sleep 1
    ds_read_b32 v17, v18
    s_waitcnt lgkmcnt(0)
    v_cmp_gt_u32 vcc, 4, v17
    s_nop 0
    s_cbranch_vccz BACK_59
    s_sub_u32 s12, s12, 1
    s_cbranch_scc0 SPIN_58_a
    s_branch BACK_59
SPIN_60:
    s_mov_b32 s12, 2097152
SPIN_60_a:
    s_sleep 1
    ds_read_b32 v17, v18
    s_waitcnt lgkmcnt(0)
    v_cmp_gt_u32 vcc, 7, v17
    s_nop 0
    s_cbranch_vccz BACK_61
    s_sub_u32 s12, s12, 1
    s_cbranch_scc0 SPIN_60_a
    s_branch BACK_61
SPIN_64:
    s_mov_b32 s12, 2097152
SPIN_64_a:
    s_sleep 1
    ds_read_b32 v17, v18
    s_waitcnt lgkmcnt(0)
    v_cmp_gt_u32 vcc, 9, v17
    s_nop 0
    s_cbranch_vccz BACK_65
    s_sub_u32 s12, s12, 1
    s_cbranch_scc0 SPIN_64_a
    s_branch BACK_65
SPIN_66:
    s_mov_b32 s12, 2097152
SPIN_66_a:
    s_sleep 1
    ds_read_b32 v17, v16
    s_waitcnt lgkmcnt(0)
    v_cmp_gt_u32 vcc, 2, v17
    s_nop 0
    s_cbranch_vccz BACK_67
    s_sub_u32 s12, s12, 1
    s_cbranch_scc0 SPIN_66_a
    s_branch BACK_67
SPIN_69:
    s_mov_b32 s12, 2097152
SPIN_69_a:
    s_sleep 1
    ds_read_b32 v17, v18
    s_waitcnt lgkmcnt(0)
    v_cmp_gt_u32 vcc, 10, v17
    s_nop 0
    s_cbranch_vccz BACK_70
    s_sub_u32 s12, s12, 1
    s_cbranch_scc0 SPIN_69_a
    s_branch BACK_70
SPIN_71:
    s_mov_b32 s12, 2097152
SPIN_71_a:
    s_sleep 1
    ds_read_b32 v17, v18
    s_waitcnt lgkmcnt(0)
    v_cmp_gt_u32 vcc, 11, v17
    s_nop 0
    s_cbranch_vccz BACK_72
    s_sub_u32 s12, s12, 1
    s_cbranch_scc0 SPIN_71_a
    s_branch BACK_72
SPIN_73:
    s_mov_b32 s12, 2097152
SPIN_73_a:
    s_sleep 1
    ds_read_b32 v17, v18
    s_waitcnt lgkmcnt(0)
    v_cmp_gt_u32 vcc, 12, v17
    s_nop 0
    s_cbranch_vccz BACK_74
    s_sub_u32 s12, s12, 1
    s_cbranch_scc0 SPIN_73_a
    s_branch BACK_74
SPIN_76:
    s_mov_b32 s12, 2097152
SPIN_76_a:
    s_sleep 1
    ds_read_b32 v17, v18
    s_waitcnt lgkmcnt(0)
    v_cmp_gt_u32 vcc, 13, v17
    s_nop 0
    s_cbranch_vccz BACK_77
    s_sub_u32 s12, s12, 1
    s_cbranch_scc0 SPIN_76_a
L_LAST:
    s_branch BACK_77
.section .rodata,"a"
.p2align 6
.amdhsa_kernel recurrent_scan__ssm_conv_s4d__mixer_channel_mlp__prompt_kernel
  .amdhsa_next_free_vgpr 256
  .amdhsa_next_free_sgpr 102
  .amdhsa_accum_offset 256
  .amdhsa_group_segment_fixed_size 0
  .amdhsa_kernarg_size 120
  .amdhsa_user_sgpr_count 2
  .amdhsa_user_sgpr_kernarg_segment_ptr 1
  .amdhsa_system_sgpr_workgroup_id_x 1
.end_amdhsa_kernel
```
